```python
import torch

def _softmax(x, axis=-1):
    return torch.softmax(x, dim=axis)
def _gelu(x):
    return torch.nn.functional.gelu(x, approximate="tanh")
def _silu(x):
    return torch.nn.functional.silu(x)
def _sigmoid(x):
    return torch.sigmoid(x)
def _layernorm(x, axis=-1, eps=1e-5):
    m = x.mean(dim=axis, keepdim=True)
    v = x.var(dim=axis, keepdim=True, unbiased=False)
    return (x - m) / torch.sqrt(v + eps)
def _scatter_add(tgt, idx, src, axis=0):
    return tgt.clone().index_add_(axis, idx, src)
def _segment_sum(src, seg, n):
    out = torch.zeros((n,) + src.shape[1:], dtype=src.dtype)
    return out.index_add_(0, seg, src)
def _pad(x, pw):
    flat = tuple(v for pair in reversed(pw) for v in pair)
    return torch.nn.functional.pad(x, flat)

kernel_name = 'parallel_sum__sliding_block_cached__glu_gated_reglu__decode'

def setup_inputs():

    _w = (lambda a: (lambda t: t.to(torch.bfloat16) if t.is_floating_point() else t)(torch.as_tensor(a)))
    def _A_setup():
        B, Sq, D = 2, 1, 512
        Hq, Hkv, Sk, Dh = 32, 8, 32768, 128
        assert Hq % Hkv == 0, (Hq, Hkv)
        return {
            "x": _w((lambda *s: torch.randn(*s, dtype=torch.bfloat16) * 0.05)(B, Sq, D)),
            "k_cache": _w((lambda *s: torch.randn(*s, dtype=torch.bfloat16) * 1.6)(B, Hkv, Sk, Dh)),
            "v_cache": _w((lambda *s: torch.randn(*s, dtype=torch.bfloat16) * 0.8)(B, Hkv, Sk, Dh)),
            "wq": _w((lambda *s: torch.randn(*s, dtype=torch.bfloat16) * 1.6)(D, Hq * Dh) * (D ** -0.5)),
            "wo": _w((lambda *s: torch.randn(*s, dtype=torch.bfloat16) * 0.8)(Hq * Dh, D) * ((Hq * Dh) ** -0.5)),
        }
    _A_in = _A_setup()

    def _B_setup():
        B, S, D, F = 2, 1, 512, 1792
        return {
            "x": _w((lambda *s: torch.randn(*s, dtype=torch.bfloat16) * 0.05)(B, S, D)),
            "W_gate": _w((lambda *s: torch.randn(*s, dtype=torch.bfloat16) * 0.4)(D, F) * (2.0 / D) ** 0.5),
            "W_up": _w((lambda *s: torch.randn(*s, dtype=torch.bfloat16) * 0.4)(D, F) * (2.0 / D) ** 0.5),
            "W_down": _w((lambda *s: torch.randn(*s, dtype=torch.bfloat16) * 0.4)(F, D) * (1.0 / F) ** 0.5),
        }
    _B_in = _B_setup()

    return {
        "A_x": _A_in["x"],
        "A_k_cache": _A_in["k_cache"],
        "A_v_cache": _A_in["v_cache"],
        "A_wq": _A_in["wq"],
        "A_wo": _A_in["wo"],
        "B_x": _B_in["x"],
        "B_W_gate": _B_in["W_gate"],
        "B_W_up": _B_in["W_up"],
        "B_W_down": _B_in["W_down"],
    }

def reference(A_x, A_k_cache, A_v_cache, A_wq, A_wo, B_x, B_W_gate, B_W_up, B_W_down):
    def _A_ref(x, k_cache, v_cache, wq, wo):
        B, Sq, D = x.shape
        Hq, Dh = 32, 128
        Hkv, Sk = k_cache.shape[1], k_cache.shape[2]
        W = min(4096, max(256, Sk // 4))
        rep = Hq // Hkv
        q = (lambda x, *d: x.permute(*d))((x @ wq).reshape(B, Sq, Hq, Dh), 0, 2, 1, 3)
        k = (lambda x, n, axis: torch.repeat_interleave(x, n, dim=axis))(k_cache[:, :, Sk - W:, :], rep, axis=1)
        v = (lambda x, n, axis: torch.repeat_interleave(x, n, dim=axis))(v_cache[:, :, Sk - W:, :], rep, axis=1)
        scores = torch.einsum("bhqd,bhkd->bhqk", q, k) * (Dh ** -0.5)
        p = _softmax(scores, axis=-1)
        o = torch.einsum("bhqk,bhkd->bhqd", p, v)
        return (lambda x, *d: x.permute(*d))(o, 0, 2, 1, 3).reshape(B, Sq, Hq * Dh) @ wo

    def _B_ref(x, W_gate, W_up, W_down):
        gate = torch.einsum("bsd,df->bsf", x, W_gate)
        up = torch.einsum("bsd,df->bsf", x, W_up)
        gate = gate * (lambda x, dt: x.to(dt))(gate > 0, gate.dtype)
        h = gate * up
        return torch.einsum("bsf,fd->bsd", h, W_down)

    x = A_x
    xn = _layernorm(x, axis=-1)
    return x + _A_ref(xn, A_k_cache, A_v_cache, A_wq, A_wo) + _B_ref(xn, B_W_gate, B_W_up, B_W_down)
```

```asm
; @launch grid=(256,1,1) block=(448,1,1) lds=114688
.amdgcn_target "amdgcn-amd-amdhsa--gfx950"
.text
.globl parallel_sum__sliding_block_cached__glu_gated_reglu__decode_kernel
.p2align 8
.type parallel_sum__sliding_block_cached__glu_gated_reglu__decode_kernel,@function
parallel_sum__sliding_block_cached__glu_gated_reglu__decode_kernel:
    s_load_dwordx8 s[8:15], s[0:1], 0
    s_getpc_b64 s[52:53]
PCREF:
    s_cmpk_ge_u32 s2, 256
    s_cbranch_scc1 END
    v_lshrrev_b32 v1, 6, v0
    v_and_b32 v2, 63, v0
    v_readfirstlane_b32 s3, v1
    v_and_b32 v3, 15, v2
    v_lshrrev_b32 v4, 4, v2
    s_lshr_b32 s34, s2, 5
    s_sub_u32 s3, s3, 3
    s_cbranch_scc0 ATT1
    s_cmpk_ge_u32 s2, 16
    s_cbranch_scc1 NOPF
    v_mul_u32_u24 v1, 60, v0
    global_load_dword v255, v1, s[52:53]
NOPF:
    s_cmp_eq_u32 s3, -3
    s_cbranch_scc1 HELP
    s_cmp_eq_u32 s3, -2
    s_cbranch_scc1 HELPB
    v_lshlrev_b32 v6, 5, v2
    s_waitcnt lgkmcnt(0)
    global_load_dwordx4 v[208:211], v6, s[8:9]
    global_load_dwordx4 v[212:215], v6, s[8:9] offset:16
    s_branch AUX
ATT1:
    s_and_b32 s32, s2, 7
    s_bfe_u32 s45, s2, 0x20003
    s_lshl2_add_u32 s5, s32, s45
    s_lshl_b32 s5, s5, 8
    s_lshl4_add_u32 s4, s34, s3
    s_lshl_b32 s4, s4, 15
    s_add_u32 s4, s4, s5
    v_lshlrev_b32 v7, 17, v4
    v_lshl_add_u32 v7, v3, 4, v7
    v_add_u32 v7, s4, v7
    s_add_u32 s4, s3, 20
    s_lshl_b32 m0, s4, 12
    s_movk_i32 s41, 7168
    s_waitcnt lgkmcnt(0)
    global_load_lds_dwordx4 v7, s[14:15] offset:0 nt
    v_add_u32 v7, s41, v7
    global_load_lds_dwordx4 v7, s[14:15] offset:1024 nt
    v_add_u32 v7, s41, v7
    global_load_lds_dwordx4 v7, s[14:15] offset:2048 nt
    v_add_u32 v7, s41, v7
    global_load_lds_dwordx4 v7, s[14:15] offset:3072 nt
    s_branch ATT2
HELPB:
    s_load_dwordx16 s[16:31], s[0:1], 32
    s_mov_b64 exec, 0
    s_branch PADB0
    .p2align 8
HELP:
    v_mov_b32 v253, 0
    v_lshlrev_b32 v9, 2, v2
    ds_write_b32 v9, v253 offset:2816
    s_waitcnt lgkmcnt(0)
    s_barrier
    s_mov_b64 exec, 0
    s_branch PADA0
HBBAR:
    s_barrier
    s_branch PADC0
AUX:
    s_load_dwordx16 s[16:31], s[0:1], 32
    v_mov_b32 v253, 0
    s_and_b32 s32, s2, 7
    s_lshr_b32 s33, s2, 3
    s_and_b32 s45, s33, 3
    s_mov_b32 s37, 0xffffff00
    s_mov_b32 s40, 200000
    s_lshl_b32 s35, s32, 2
    s_add_u32 s35, s35, s45
    v_and_b32 v12, 1, v4
    v_lshlrev_b32 v12, 4, v12
    v_lshl_add_u32 v12, v3, 5, v12
    v_lshrrev_b32 v13, 1, v4
    s_lshl_b32 s5, s35, 3
    s_add_u32 s5, s5, s34
    s_lshl_b32 s5, s5, 9
    s_add_u32 s5, s5, 1052672
    v_lshlrev_b32 v14, 17, v13
    v_add3_u32 v14, v14, v12, s5
    v_lshlrev_b32 v7, 4, v2
    v_add_u32 v7, 81920, v7
    s_getreg_b32 s50, hwreg(HW_REG_XCC_ID, 0, 4)
    v_lshrrev_b32 v8, 3, v3
    v_lshlrev_b32 v8, 5, v8
    s_lshl_b32 s4, s34, 2
    v_add3_u32 v8, v8, v4, s4
    v_lshlrev_b32 v8, 2, v8
    v_and_b32 v9, 1, v3
    v_lshlrev_b32 v9, 4, v9
    v_mov_b32 v10, 0xffff
    v_lshlrev_b32 v9, v9, v10
    v_bfe_u32 v10, v3, 1, 2
    v_cmp_eq_u32 vcc, 0, v10
    s_nop 1
    v_cndmask_b32 v224, 0, v9, vcc
    v_cmp_eq_u32 vcc, 1, v10
    s_nop 1
    v_cndmask_b32 v225, 0, v9, vcc
    v_cmp_eq_u32 vcc, 2, v10
    s_nop 1
    v_cndmask_b32 v226, 0, v9, vcc
    v_cmp_eq_u32 vcc, 3, v10
    s_nop 1
    v_cndmask_b32 v227, 0, v9, vcc
    s_mov_b32 s4, 0x01000100
    s_mov_b32 s5, 0x03020302
    v_mov_b32 v9, 0x0c0c0c0c
    v_bfi_b32 v96, v224, s4, v9
    v_bfi_b32 v100, v224, s5, v9
    v_bfi_b32 v97, v225, s4, v9
    v_bfi_b32 v101, v225, s5, v9
    v_bfi_b32 v98, v226, s4, v9
    v_bfi_b32 v102, v226, s5, v9
    v_bfi_b32 v99, v227, s4, v9
    v_bfi_b32 v103, v227, s5, v9
    s_waitcnt lgkmcnt(0)
    s_load_dword s38, s[30:31], 0
    s_barrier
    s_branch AUX2
ATT2:
    s_load_dwordx16 s[16:31], s[0:1], 32
    s_lshl_b32 s54, s3, 12
    s_and_b32 s4, s2, 15
    s_lshl_b32 s4, s4, 23
    s_lshr_b32 s35, s2, 4
    s_lshl_b32 s5, s35, 16
    s_add_u32 s4, s4, s5
    s_add_u32 s4, s4, s54
    s_add_u32 s4, s4, 7340032
    s_lshl_b32 s5, s45, 14
    s_xor_b32 s4, s4, s5
    s_mov_b32 s5, s3
    s_and_b32 s5, s5, 3
    s_lshl_b32 s5, s5, 10
    s_xor_b32 s4, s4, s5
    v_lshlrev_b32 v6, 8, v4
    v_add_u32 v6, s4, v6
    v_lshlrev_b32 v8, 2, v4
    v_xor_b32 v8, v8, v3
    v_lshl_add_u32 v8, v8, 4, v6
    s_lshl_b32 s41, s3, 14
    s_add_u32 m0, s41, 16384
    s_movk_i32 s44, 0x400
    v_lshl_add_u32 v7, v3, 4, v6
    v_mov_b32 v253, 0
    v_mov_b32 v254, 1
    s_lshr_b32 s33, s2, 3
    s_and_b32 s46, s33, 1
    s_mov_b32 s37, 0xffffff00
    s_mov_b32 s40, 200000
    s_lshl_b32 s5, s32, 1
    s_lshr_b32 s6, s45, 1
    s_add_u32 s5, s5, s6
    s_lshl_b32 s5, s5, 8
    s_mul_i32 s4, s34, 229376
    s_add_u32 s4, s4, s5
    s_mul_i32 s5, s3, 14336
    s_add_u32 s4, s4, s5
    v_mul_u32_u24 v14, 57344, v4
    v_lshl_add_u32 v14, v3, 4, v14
    v_add_u32 v14, s4, v14
    s_movk_i32 s55, 2560
    s_waitcnt lgkmcnt(0)
    s_load_dword s38, s[30:31], 0
    s_bitcmp1_b32 s45, 0
    s_cselect_b64 s[6:7], s[22:23], s[20:21]
    s_barrier
    s_waitcnt vmcnt(3)
    global_load_lds_dwordx4 v8, s[10:11] nt
    s_add_u32 m0, m0, s44
    v_xor_b32 v8, 0x410, v8
    s_waitcnt vmcnt(3)
    global_load_lds_dwordx4 v8, s[10:11] nt
    s_add_u32 m0, m0, s44
    v_xor_b32 v8, 0xc30, v8
    s_waitcnt vmcnt(3)
    global_load_lds_dwordx4 v8, s[10:11] nt
    s_add_u32 m0, m0, s44
    v_xor_b32 v8, 0x410, v8
    s_waitcnt vmcnt(3)
    s_mov_b64 exec, 1
    ds_add_u32 v253, v254 offset:2816
    s_mov_b64 exec, -1
    global_load_lds_dwordx4 v8, s[10:11] nt
    v_xor_b32 v8, 0x4c30, v8
    s_add_u32 m0, s41, 20480
    s_waitcnt vmcnt(5)
    global_load_lds_dwordx4 v8, s[10:11] nt
    s_add_u32 m0, m0, s44
    v_xor_b32 v8, 0x410, v8
    s_waitcnt vmcnt(5)
    global_load_lds_dwordx4 v8, s[10:11] nt
    s_add_u32 m0, m0, s44
    v_xor_b32 v8, 0xc30, v8
    s_waitcnt vmcnt(5)
    global_load_lds_dwordx4 v8, s[10:11] nt
    s_add_u32 m0, m0, s44
    v_xor_b32 v8, 0x410, v8
    s_waitcnt vmcnt(5)
    global_load_lds_dwordx4 v8, s[10:11] nt
    v_xor_b32 v8, 0xcc30, v8
    s_add_u32 m0, s41, 24576
    s_waitcnt vmcnt(5)
    global_load_lds_dwordx4 v8, s[10:11] nt
    s_add_u32 m0, m0, s44
    v_xor_b32 v8, 0x410, v8
    s_waitcnt vmcnt(5)
    s_mov_b64 exec, 1
    ds_add_u32 v253, v254 offset:2820
    s_mov_b64 exec, -1
    global_load_lds_dwordx4 v8, s[10:11] nt
    s_add_u32 m0, m0, s44
    v_xor_b32 v8, 0xc30, v8
    s_waitcnt vmcnt(5)
    global_load_lds_dwordx4 v8, s[10:11] nt
    s_add_u32 m0, m0, s44
    v_xor_b32 v8, 0x410, v8
    s_waitcnt vmcnt(5)
    global_load_lds_dwordx4 v8, s[10:11] nt
    v_xor_b32 v8, 0x4c30, v8
    s_cmp_eq_u32 s32, 7
    s_cbranch_scc1 NOGU
    s_add_u32 m0, s54, 98304
    s_waitcnt vmcnt(5)
    global_load_lds_dwordx4 v14, s[6:7] offset:0 nt
    v_add_u32 v14, s55, v14
    s_waitcnt vmcnt(5)
    global_load_lds_dwordx4 v14, s[6:7] offset:1024 nt
    v_add_u32 v14, s55, v14
    s_waitcnt vmcnt(5)
    global_load_lds_dwordx4 v14, s[6:7] offset:2048 nt
    v_add_u32 v14, s55, v14
    s_waitcnt vmcnt(5)
    global_load_lds_dwordx4 v14, s[6:7] offset:3072 nt
NOGU:
    s_add_u32 m0, s41, 28672
    s_waitcnt vmcnt(5)
    global_load_lds_dwordx4 v8, s[10:11] nt
    s_add_u32 m0, m0, s44
    v_xor_b32 v8, 0x410, v8
    s_waitcnt vmcnt(5)
    global_load_lds_dwordx4 v8, s[10:11] nt
    s_add_u32 m0, m0, s44
    v_xor_b32 v8, 0xc30, v8
    s_waitcnt vmcnt(5)
    global_load_lds_dwordx4 v8, s[10:11] nt
    s_add_u32 m0, m0, s44
    v_xor_b32 v8, 0x410, v8
    s_waitcnt vmcnt(5)
    global_load_lds_dwordx4 v8, s[10:11] nt
    s_waitcnt vmcnt(5)
    global_load_dwordx4 v[16:19], v7, s[12:13] nt
    v_xor_b32 v7, 0x400, v7
    v_and_b32 v9, 1, v3
    v_lshlrev_b32 v9, 4, v9
    v_mov_b32 v10, 0xffff
    v_lshlrev_b32 v9, v9, v10
    v_bfe_u32 v10, v3, 1, 2
    v_cmp_eq_u32 vcc, 0, v10
    s_nop 1
    v_cndmask_b32 v248, 0, v9, vcc
    v_cmp_eq_u32 vcc, 1, v10
    s_nop 1
    v_cndmask_b32 v249, 0, v9, vcc
PADA3:
    s_cbranch_execz END
    v_cmp_eq_u32 vcc, 2, v10
    s_nop 1
    v_cndmask_b32 v250, 0, v9, vcc
    v_cmp_eq_u32 vcc, 3, v10
    s_nop 1
    v_cndmask_b32 v251, 0, v9, vcc
    s_waitcnt vmcnt(5)
    s_mov_b64 exec, 1
    ds_add_u32 v253, v254 offset:2824
    s_mov_b64 exec, -1
    global_load_dwordx4 v[20:23], v7, s[12:13] nt
    v_xor_b32 v7, 0xc00, v7
    v_and_b32 v12, 3, v3
    v_lshrrev_b32 v9, 2, v3
    v_lshl_add_u32 v8, v12, 2, v9
    v_lshlrev_b32 v8, 8, v8
    v_xor_b32 v9, v4, v3
    v_lshl_add_u32 v8, v9, 4, v8
    v_add_u32 v8, s41, v8
    v_xor_b32 v9, 64, v8
    v_xor_b32 v10, 0x80, v8
    v_xor_b32 v11, 0xc0, v8
    v_mul_u32_u24 v13, 320, v12
    v_lshl_add_u32 v13, v4, 4, v13
    v_mov_b32 v228, 0x3f803f80
    v_mov_b32 v229, 0x3f803f80
    v_mov_b32 v230, 0x3f803f80
    v_mov_b32 v231, 0x3f803f80
    s_mov_b32 s42, 0x3db504f3
    s_mov_b32 s43, 0x3fb8aa3b
    s_mov_b32 s48, 0x05040100
    s_mov_b32 s49, 0x07060302
    v_lshlrev_b32 v14, 6, v12
    s_lshl_b32 s5, s3, 4
    v_lshl_add_u32 v15, v4, 2, v14
    v_add_u32 v15, s5, v15
    s_waitcnt vmcnt(5)
    global_load_dwordx4 v[24:27], v7, s[12:13] nt
    v_xor_b32 v7, 0x400, v7
    s_lshl_b32 s4, s32, 19
    s_and_b32 s6, s34, 3
    s_lshl_b32 s6, s6, 11
    s_add_u32 s4, s4, s6
    s_lshr_b32 s6, s34, 2
    s_lshl_b32 s6, s6, 10
    s_add_u32 s4, s4, s6
    s_lshl_b32 s6, s3, 15
    s_add_u32 s4, s4, s6
    s_lshl_b32 s6, s45, 8
    s_add_u32 s4, s4, s6
    v_lshlrev_b32 v6, 17, v4
    v_lshl_add_u32 v6, v3, 4, v6
    v_add_u32 v6, s4, v6
    s_lshl_b32 s4, s32, 1
    s_add_u32 s4, s4, s46
    s_lshl_b32 s4, s4, 4
    s_add_u32 s4, s4, s35
    s_lshl_b32 s4, s4, 11
    s_lshl_b32 s6, s3, 9
    s_add_u32 s4, s4, s6
    s_add_u32 s4, s4, 524288
    v_lshlrev_b32 v252, 4, v2
    v_add_u32 v252, s4, v252
    s_waitcnt vmcnt(5)
    global_load_dwordx4 v[28:31], v7, s[12:13] nt
    v_xor_b32 v7, 0x4c00, v7
    s_waitcnt vmcnt(5)
    global_load_dwordx4 v[32:35], v7, s[12:13] nt
    v_xor_b32 v7, 0x400, v7
    s_waitcnt vmcnt(5)
    global_load_dwordx4 v[36:39], v7, s[12:13] nt
    v_xor_b32 v7, 0xc00, v7
    ds_read_b128 v[80:83], v8 offset:16384
    ds_read_b128 v[84:87], v9 offset:16384
    ds_read_b128 v[88:91], v10 offset:16384
    ds_read_b128 v[92:95], v11 offset:16384
    ds_read_b128 v[96:99], v8 offset:20480
    ds_read_b128 v[100:103], v9 offset:20480
    ds_read_b128 v[104:107], v10 offset:20480
    ds_read_b128 v[108:111], v11 offset:20480
    ds_read_b128 v[112:115], v8 offset:24576
    ds_read_b128 v[116:119], v9 offset:24576
    ds_read_b128 v[120:123], v10 offset:24576
    ds_read_b128 v[124:127], v11 offset:24576
    ds_read_b128 v[128:131], v8 offset:28672
    ds_read_b128 v[132:135], v9 offset:28672
    ds_read_b128 v[136:139], v10 offset:28672
    ds_read_b128 v[140:143], v11 offset:28672
AW1:
    ds_read_b32 v232, v253 offset:2828
    s_waitcnt lgkmcnt(0)
    v_cmp_gt_u32 vcc, 1, v232
    s_cbranch_vccnz AW1
    ds_read_b128 v[144:147], v13 offset:0
    ds_read_b128 v[148:151], v13 offset:64
    ds_read_b128 v[152:155], v13 offset:128
    ds_read_b128 v[156:159], v13 offset:192
    v_readfirstlane_b32 s51, v232
    s_lshr_b32 s51, s51, 1
    s_cbranch_scc0 NOPRE
    v_mov_b32 v216, s38
    s_mov_b32 exec_hi, 0
    global_store_dword v252, v216, s[30:31]
    global_load_dword v255, v252, s[30:31] sc1 nt
    s_mov_b32 exec_hi, -1
NOPRE:
    global_load_dwordx4 v[40:43], v7, s[12:13] nt
    v_xor_b32 v7, 0x400, v7
    s_waitcnt lgkmcnt(3)
    v_mfma_f32_16x16x32_bf16 v[160:163], v[80:83], v[144:147], 0
    v_mfma_f32_16x16x32_bf16 v[164:167], v[96:99], v[144:147], 0
    v_mfma_f32_16x16x32_bf16 v[168:171], v[112:115], v[144:147], 0
    v_mfma_f32_16x16x32_bf16 v[172:175], v[128:131], v[144:147], 0
    s_waitcnt lgkmcnt(2)
    v_mfma_f32_16x16x32_bf16 v[160:163], v[84:87], v[148:151], v[160:163]
    v_mfma_f32_16x16x32_bf16 v[164:167], v[100:103], v[148:151], v[164:167]
    v_mfma_f32_16x16x32_bf16 v[168:171], v[116:119], v[148:151], v[168:171]
    v_mfma_f32_16x16x32_bf16 v[172:175], v[132:135], v[148:151], v[172:175]
    s_waitcnt lgkmcnt(1)
    v_mfma_f32_16x16x32_bf16 v[160:163], v[88:91], v[152:155], v[160:163]
    v_mfma_f32_16x16x32_bf16 v[164:167], v[104:107], v[152:155], v[164:167]
    v_mfma_f32_16x16x32_bf16 v[168:171], v[120:123], v[152:155], v[168:171]
    v_mfma_f32_16x16x32_bf16 v[172:175], v[136:139], v[152:155], v[172:175]
    s_waitcnt lgkmcnt(0)
    v_mfma_f32_16x16x32_bf16 v[160:163], v[92:95], v[156:159], v[160:163]
    v_mfma_f32_16x16x32_bf16 v[164:167], v[108:111], v[156:159], v[164:167]
    v_mfma_f32_16x16x32_bf16 v[168:171], v[124:127], v[156:159], v[168:171]
    v_mfma_f32_16x16x32_bf16 v[172:175], v[140:143], v[156:159], v[172:175]
    global_load_dwordx4 v[44:47], v7, s[12:13] nt
    v_xor_b32 v7, 0xcc00, v7
    s_nop 4
    v_cvt_pk_bf16_f32 v232, v160, v161
    v_lshlrev_b32 v160, 16, v232
    v_and_b32 v161, 0xffff0000, v232
    v_pk_mul_f32 v[160:161], v[160:161], s[42:43] op_sel_hi:[1,0]
    v_cvt_pk_bf16_f32 v232, v160, v161
    v_lshlrev_b32 v160, 16, v232
    v_and_b32 v161, 0xffff0000, v232
    v_max_f32 v233, v160, v161
    v_cvt_pk_bf16_f32 v232, v162, v163
    v_lshlrev_b32 v162, 16, v232
    v_and_b32 v163, 0xffff0000, v232
    v_pk_mul_f32 v[162:163], v[162:163], s[42:43] op_sel_hi:[1,0]
    v_cvt_pk_bf16_f32 v232, v162, v163
    v_lshlrev_b32 v162, 16, v232
    v_and_b32 v163, 0xffff0000, v232
    v_max3_f32 v233, v233, v162, v163
    v_cvt_pk_bf16_f32 v232, v164, v165
    v_lshlrev_b32 v164, 16, v232
    v_and_b32 v165, 0xffff0000, v232
    v_pk_mul_f32 v[164:165], v[164:165], s[42:43] op_sel_hi:[1,0]
    v_cvt_pk_bf16_f32 v232, v164, v165
    v_lshlrev_b32 v164, 16, v232
    v_and_b32 v165, 0xffff0000, v232
    v_max3_f32 v233, v233, v164, v165
    v_cvt_pk_bf16_f32 v232, v166, v167
    v_lshlrev_b32 v166, 16, v232
    v_and_b32 v167, 0xffff0000, v232
    v_pk_mul_f32 v[166:167], v[166:167], s[42:43] op_sel_hi:[1,0]
    v_cvt_pk_bf16_f32 v232, v166, v167
PADA2:
    s_cbranch_execz PADA3
    v_lshlrev_b32 v166, 16, v232
    v_and_b32 v167, 0xffff0000, v232
    v_max3_f32 v233, v233, v166, v167
    global_load_dwordx4 v[48:51], v7, s[12:13] nt
    v_xor_b32 v7, 0x400, v7
    v_cvt_pk_bf16_f32 v232, v168, v169
    v_lshlrev_b32 v168, 16, v232
    v_and_b32 v169, 0xffff0000, v232
    v_pk_mul_f32 v[168:169], v[168:169], s[42:43] op_sel_hi:[1,0]
    v_cvt_pk_bf16_f32 v232, v168, v169
    v_lshlrev_b32 v168, 16, v232
    v_and_b32 v169, 0xffff0000, v232
    v_max3_f32 v233, v233, v168, v169
    v_cvt_pk_bf16_f32 v232, v170, v171
    v_lshlrev_b32 v170, 16, v232
    v_and_b32 v171, 0xffff0000, v232
    v_pk_mul_f32 v[170:171], v[170:171], s[42:43] op_sel_hi:[1,0]
    v_cvt_pk_bf16_f32 v232, v170, v171
    v_lshlrev_b32 v170, 16, v232
    v_and_b32 v171, 0xffff0000, v232
    v_max3_f32 v233, v233, v170, v171
    v_cvt_pk_bf16_f32 v232, v172, v173
    v_lshlrev_b32 v172, 16, v232
    v_and_b32 v173, 0xffff0000, v232
    v_pk_mul_f32 v[172:173], v[172:173], s[42:43] op_sel_hi:[1,0]
    v_cvt_pk_bf16_f32 v232, v172, v173
    v_lshlrev_b32 v172, 16, v232
    v_and_b32 v173, 0xffff0000, v232
    v_max3_f32 v233, v233, v172, v173
    v_cvt_pk_bf16_f32 v232, v174, v175
    v_lshlrev_b32 v174, 16, v232
    v_and_b32 v175, 0xffff0000, v232
    v_pk_mul_f32 v[174:175], v[174:175], s[42:43] op_sel_hi:[1,0]
    v_cvt_pk_bf16_f32 v232, v174, v175
    v_lshlrev_b32 v174, 16, v232
    v_and_b32 v175, 0xffff0000, v232
    v_max3_f32 v233, v233, v174, v175
    ds_write_b32 v15, v233 offset:1536
    s_mov_b64 exec, 1
    ds_add_u32 v253, v254 offset:2832
    s_mov_b64 exec, -1
    global_load_dwordx4 v[52:55], v7, s[12:13] nt
    v_xor_b32 v7, 0xc00, v7
AW2:
    ds_read_b32 v232, v253 offset:2832
    s_waitcnt lgkmcnt(0)
    v_cmp_gt_u32 vcc, 4, v232
    s_cbranch_vccnz AW2
    ds_read_b128 v[232:235], v14 offset:1536
    ds_read_b128 v[236:239], v14 offset:1552
    ds_read_b128 v[240:243], v14 offset:1568
    ds_read_b128 v[244:247], v14 offset:1584
    v_lshlrev_b32 v12, 2, v12
    s_waitcnt lgkmcnt(0)
    v_max3_f32 v232, v232, v233, v234
    v_max3_f32 v232, v232, v235, v236
    v_max3_f32 v232, v232, v237, v238
    v_max3_f32 v232, v232, v239, v240
    v_max3_f32 v232, v232, v241, v242
    v_max3_f32 v232, v232, v243, v244
    v_max3_f32 v232, v232, v245, v246
    v_max_f32 v232, v232, v247
    ds_write_b32 v12, v232 offset:1792
    global_load_dwordx4 v[56:59], v7, s[12:13] nt
    v_xor_b32 v7, 0x400, v7
    v_mul_f32 v233, s43, v232
    v_fma_f32 v160, v160, s43, -v233
    v_fma_f32 v161, v161, s43, -v233
    v_fma_f32 v162, v162, s43, -v233
    v_fma_f32 v163, v163, s43, -v233
    v_fma_f32 v164, v164, s43, -v233
    v_fma_f32 v165, v165, s43, -v233
    v_fma_f32 v166, v166, s43, -v233
    v_fma_f32 v167, v167, s43, -v233
    v_fma_f32 v168, v168, s43, -v233
    v_fma_f32 v169, v169, s43, -v233
    v_fma_f32 v170, v170, s43, -v233
    v_fma_f32 v171, v171, s43, -v233
    v_fma_f32 v172, v172, s43, -v233
    v_fma_f32 v173, v173, s43, -v233
    v_fma_f32 v174, v174, s43, -v233
    v_fma_f32 v175, v175, s43, -v233
    v_exp_f32 v160, v160
    v_exp_f32 v161, v161
    v_exp_f32 v162, v162
    v_exp_f32 v163, v163
    v_exp_f32 v164, v164
    v_exp_f32 v165, v165
    v_exp_f32 v166, v166
    v_exp_f32 v167, v167
    v_exp_f32 v168, v168
    v_exp_f32 v169, v169
    v_exp_f32 v170, v170
    v_exp_f32 v171, v171
    v_exp_f32 v172, v172
    v_exp_f32 v173, v173
    v_exp_f32 v174, v174
    v_exp_f32 v175, v175
    global_load_dwordx4 v[60:63], v7, s[12:13] nt
    v_xor_b32 v7, 0x4c00, v7
    s_nop 0
    v_cvt_pk_bf16_f32 v208, v160, v161
    v_cvt_pk_bf16_f32 v209, v162, v163
    v_cvt_pk_bf16_f32 v210, v164, v165
    v_cvt_pk_bf16_f32 v211, v166, v167
    v_cvt_pk_bf16_f32 v212, v168, v169
    v_cvt_pk_bf16_f32 v213, v170, v171
    v_cvt_pk_bf16_f32 v214, v172, v173
    v_cvt_pk_bf16_f32 v215, v174, v175
    v_lshrrev_b32 v234, 2, v3
    v_mov_b32 v235, s5
    v_mfma_f32_16x16x32_bf16 v[224:227], v[208:211], v[228:231], 0
    v_mfma_f32_16x16x32_bf16 v[224:227], v[212:215], v[228:231], v[224:227]
    v_cmp_eq_u32 vcc, 0, v234
    s_nop 1
    v_cndmask_b32 v176, 0, v208, vcc
    v_cndmask_b32 v177, 0, v209, vcc
    v_cndmask_b32 v178, 0, v210, vcc
    v_cndmask_b32 v179, 0, v211, vcc
    v_cndmask_b32 v180, 0, v212, vcc
    v_cndmask_b32 v181, 0, v213, vcc
    v_cndmask_b32 v182, 0, v214, vcc
    v_cndmask_b32 v183, 0, v215, vcc
    ds_write_b128 v235, v[224:227] offset:1808
    s_mov_b64 exec, 1
    ds_add_u32 v253, v254 offset:2836
    s_mov_b64 exec, -1
    v_cmp_eq_u32 vcc, 1, v234
    s_nop 1
    v_cndmask_b32 v184, 0, v208, vcc
    v_cndmask_b32 v185, 0, v209, vcc
    v_cndmask_b32 v186, 0, v210, vcc
    v_cndmask_b32 v187, 0, v211, vcc
    v_cndmask_b32 v188, 0, v212, vcc
    v_cndmask_b32 v189, 0, v213, vcc
    v_cndmask_b32 v190, 0, v214, vcc
    v_cndmask_b32 v191, 0, v215, vcc
    v_cmp_eq_u32 vcc, 2, v234
    s_nop 1
    v_cndmask_b32 v192, 0, v208, vcc
    v_cndmask_b32 v193, 0, v209, vcc
    v_cndmask_b32 v194, 0, v210, vcc
    v_cndmask_b32 v195, 0, v211, vcc
    v_cndmask_b32 v196, 0, v212, vcc
    v_cndmask_b32 v197, 0, v213, vcc
    v_cndmask_b32 v198, 0, v214, vcc
    v_cndmask_b32 v199, 0, v215, vcc
    v_cmp_eq_u32 vcc, 3, v234
    s_nop 1
    v_cndmask_b32 v200, 0, v208, vcc
    v_cndmask_b32 v201, 0, v209, vcc
    v_cndmask_b32 v202, 0, v210, vcc
    v_cndmask_b32 v203, 0, v211, vcc
    v_cndmask_b32 v204, 0, v212, vcc
    v_cndmask_b32 v205, 0, v213, vcc
    v_cndmask_b32 v206, 0, v214, vcc
    v_cndmask_b32 v207, 0, v215, vcc
    global_load_dwordx4 v[64:67], v7, s[12:13] nt
    v_xor_b32 v7, 0x400, v7
    s_lshl_b32 s5, s3, 11
    v_lshlrev_b32 v15, 4, v2
    v_add_u32 v14, s5, v15
    s_lshl_b32 s5, s3, 9
    s_lshl_b32 s6, s3, 10
    v_add_u32 v12, s6, v15
    v_add_u32 v15, s5, v15
    s_lshl_b32 s4, s32, 16
    s_lshl_b32 s5, s34, 8
    s_add_u32 s4, s4, s5
    s_lshl_b32 s5, s3, 6
    s_add_u32 s4, s4, s5
PADA1:
    s_cbranch_execz PADA2
    s_add_u32 s4, s4, 524288
    v_lshrrev_b32 v1, 2, v2
    v_and_b32 v9, 3, v2
    v_lshlrev_b32 v8, 11, v1
    v_lshl_add_u32 v8, v9, 4, v8
    v_add_u32 v8, s4, v8
    v_add_u32 v9, 0x8000, v8
    v_lshlrev_b32 v1, 4, v1
    v_lshlrev_b32 v10, 4, v2
    s_lshl3_add_u32 s4, s32, s34
    s_lshl_b32 s5, s45, 6
    s_add_u32 s4, s4, s5
    s_lshl_b32 s4, s4, 10
    s_add_u32 s4, s4, 1376256
    v_lshlrev_b32 v11, 5, v3
    v_and_b32 v13, 1, v4
    v_lshl_add_u32 v11, v13, 4, v11
    v_lshrrev_b32 v13, 1, v4
    v_lshl_add_u32 v11, v13, 9, v11
    v_add_u32 v11, s4, v11
    s_add_u32 s36, s38, 1
    s_and_b32 s84, s36, 0xff
    s_bfe_u32 s4, s36, 0x80008
    s_xor_b32 s85, s4, s84
    s_bfe_u32 s4, s36, 0x80010
    s_xor_b32 s86, s4, s84
    s_bfe_u32 s4, s36, 0x80018
    s_xor_b32 s87, s4, s84
    v_mov_b32 v228, s84
    v_mov_b32 v229, s85
    v_mov_b32 v230, s86
    v_mov_b32 v231, s87
    s_mov_b32 s56, 0xff00ff00
    s_mov_b32 s57, 0xff00ff00
    s_waitcnt vmcnt(7)
    global_load_dwordx4 v[68:71], v7, s[12:13] nt
    v_xor_b32 v7, 0xc00, v7
    s_waitcnt vmcnt(7)
    global_load_dwordx4 v[72:75], v7, s[12:13] nt
    v_xor_b32 v7, 0x400, v7
    s_waitcnt vmcnt(7)
    global_load_dwordx4 v[76:79], v7, s[12:13] nt
    s_waitcnt vmcnt(8)
    v_perm_b32 v80, v20, v16, s48
    v_perm_b32 v84, v20, v16, s49
    v_perm_b32 v88, v21, v17, s48
    v_perm_b32 v92, v21, v17, s49
    v_perm_b32 v96, v22, v18, s48
    v_perm_b32 v100, v22, v18, s49
    v_perm_b32 v104, v23, v19, s48
    v_perm_b32 v108, v23, v19, s49
    v_perm_b32 v81, v28, v24, s48
    v_perm_b32 v85, v28, v24, s49
    v_perm_b32 v89, v29, v25, s48
    v_perm_b32 v93, v29, v25, s49
    v_perm_b32 v97, v30, v26, s48
    v_perm_b32 v101, v30, v26, s49
    v_perm_b32 v105, v31, v27, s48
    v_perm_b32 v109, v31, v27, s49
    v_perm_b32 v82, v36, v32, s48
    v_perm_b32 v86, v36, v32, s49
    v_perm_b32 v90, v37, v33, s48
    v_perm_b32 v94, v37, v33, s49
    v_perm_b32 v98, v38, v34, s48
    v_perm_b32 v102, v38, v34, s49
    v_perm_b32 v106, v39, v35, s48
    v_perm_b32 v110, v39, v35, s49
    v_perm_b32 v83, v44, v40, s48
    v_perm_b32 v87, v44, v40, s49
    v_perm_b32 v91, v45, v41, s48
    v_perm_b32 v95, v45, v41, s49
    v_perm_b32 v99, v46, v42, s48
    v_perm_b32 v103, v46, v42, s49
    v_perm_b32 v107, v47, v43, s48
    v_perm_b32 v111, v47, v43, s49
    v_mfma_f32_16x16x32_bf16 v[216:219], v[176:179], v[80:83], 0
    v_mfma_f32_16x16x32_bf16 v[220:223], v[176:179], v[84:87], 0
    v_mfma_f32_16x16x32_bf16 v[216:219], v[184:187], v[88:91], v[216:219]
    v_mfma_f32_16x16x32_bf16 v[220:223], v[184:187], v[92:95], v[220:223]
    v_mfma_f32_16x16x32_bf16 v[216:219], v[192:195], v[96:99], v[216:219]
    v_mfma_f32_16x16x32_bf16 v[220:223], v[192:195], v[100:103], v[220:223]
    v_mfma_f32_16x16x32_bf16 v[216:219], v[200:203], v[104:107], v[216:219]
    v_mfma_f32_16x16x32_bf16 v[220:223], v[200:203], v[108:111], v[220:223]
    s_waitcnt vmcnt(6)
    v_perm_b32 v112, v52, v48, s48
    v_perm_b32 v116, v52, v48, s49
    v_perm_b32 v120, v53, v49, s48
    v_perm_b32 v124, v53, v49, s49
    v_perm_b32 v128, v54, v50, s48
    v_perm_b32 v132, v54, v50, s49
    v_perm_b32 v136, v55, v51, s48
    v_perm_b32 v140, v55, v51, s49
    s_waitcnt vmcnt(4)
    s_mov_b64 exec, 1
    ds_add_u32 v253, v254 offset:2844
    s_mov_b64 exec, -1
    v_perm_b32 v113, v60, v56, s48
    v_perm_b32 v117, v60, v56, s49
    v_perm_b32 v121, v61, v57, s48
    v_perm_b32 v125, v61, v57, s49
    v_perm_b32 v129, v62, v58, s48
    v_perm_b32 v133, v62, v58, s49
    v_perm_b32 v137, v63, v59, s48
    v_perm_b32 v141, v63, v59, s49
    s_waitcnt vmcnt(2)
    global_load_dwordx4 v[144:147], v6, s[16:17] nt
    v_add_u32 v6, 0x2000, v6
    global_load_dwordx4 v[148:151], v6, s[16:17] nt
    v_add_u32 v6, 0x2000, v6
    global_load_dwordx4 v[152:155], v6, s[16:17] nt
    v_add_u32 v6, 0x2000, v6
    global_load_dwordx4 v[156:159], v6, s[16:17] nt
    v_perm_b32 v114, v68, v64, s48
    v_perm_b32 v118, v68, v64, s49
    v_perm_b32 v122, v69, v65, s48
    v_perm_b32 v126, v69, v65, s49
    v_perm_b32 v130, v70, v66, s48
    v_perm_b32 v134, v70, v66, s49
    v_perm_b32 v138, v71, v67, s48
    v_perm_b32 v142, v71, v67, s49
    s_waitcnt vmcnt(4)
    v_perm_b32 v115, v76, v72, s48
    v_perm_b32 v119, v76, v72, s49
    v_perm_b32 v123, v77, v73, s48
    v_mfma_f32_16x16x32_bf16 v[216:219], v[180:183], v[112:115], v[216:219]
    v_perm_b32 v127, v77, v73, s49
    v_mfma_f32_16x16x32_bf16 v[220:223], v[180:183], v[116:119], v[220:223]
    v_perm_b32 v131, v78, v74, s48
    v_mfma_f32_16x16x32_bf16 v[216:219], v[188:191], v[120:123], v[216:219]
    v_perm_b32 v135, v78, v74, s49
    v_mfma_f32_16x16x32_bf16 v[220:223], v[188:191], v[124:127], v[220:223]
    v_perm_b32 v139, v79, v75, s48
    v_mfma_f32_16x16x32_bf16 v[216:219], v[196:199], v[128:131], v[216:219]
    v_perm_b32 v143, v79, v75, s49
    v_mfma_f32_16x16x32_bf16 v[220:223], v[196:199], v[132:135], v[220:223]
    v_mfma_f32_16x16x32_bf16 v[216:219], v[204:207], v[136:139], v[216:219]
    v_mfma_f32_16x16x32_bf16 v[220:223], v[204:207], v[140:143], v[220:223]
    s_nop 6
    ds_write_b128 v14, v[216:219] offset:4096
    ds_write_b128 v14, v[220:223] offset:5120
    s_mov_b64 exec, 1
    ds_add_u32 v253, v254 offset:2840
PADA0:
    s_cbranch_execz PADA1
    s_mov_b32 exec_lo, -1
CL3:
    ds_read_b32 v224, v253 offset:2840
    ds_read_b128 v[232:235], v15 offset:4096
    ds_read_b128 v[236:239], v15 offset:6144
    ds_read_b128 v[240:243], v15 offset:8192
    ds_read_b128 v[244:247], v15 offset:10240
    s_waitcnt lgkmcnt(4)
    v_cmp_gt_u32 vcc, 4, v224
    s_cbranch_vccnz CL3
    s_waitcnt lgkmcnt(2)
    v_pk_add_f32 v[232:233], v[232:233], v[236:237]
    v_pk_add_f32 v[234:235], v[234:235], v[238:239]
    s_waitcnt lgkmcnt(0)
    v_pk_add_f32 v[240:241], v[240:241], v[244:245]
    v_pk_add_f32 v[242:243], v[242:243], v[246:247]
    v_pk_add_f32 v[232:233], v[232:233], v[240:241]
    v_pk_add_f32 v[234:235], v[234:235], v[242:243]
    v_and_or_b32 v232, v232, s37, v228
    v_and_or_b32 v233, v233, s37, v229
    v_and_or_b32 v234, v234, s37, v230
    v_and_or_b32 v235, v235, s37, v231
    s_cmp_eq_u32 s51, 0
    s_cbranch_scc1 CS4
    global_store_dwordx4 v252, v[232:235], s[30:31]
CS5:
    s_mov_b32 exec_hi, -1
OG6:
    global_load_dwordx4 v[168:171], v8, s[30:31] sc1
    global_load_dwordx4 v[172:175], v9, s[30:31] sc1
    s_waitcnt vmcnt(1)
    ds_read_b32 v217, v253 offset:2848
    ds_read_b128 v[160:163], v1 offset:2304
    ds_read_b128 v[164:167], v1 offset:2560
    v_xor_b32 v168, s84, v168
    v_xor_b32 v169, s85, v169
    v_xor_b32 v170, s86, v170
    v_xor_b32 v171, s87, v171
    s_waitcnt vmcnt(0)
    v_xor_b32 v172, s84, v172
    v_xor_b32 v173, s85, v173
    v_xor_b32 v174, s86, v174
    v_xor_b32 v175, s87, v175
    v_or3_b32 v216, v168, v169, v170
    v_or3_b32 v216, v216, v171, v172
    v_or3_b32 v216, v216, v173, v174
    v_or_b32 v216, v216, v175
    s_waitcnt lgkmcnt(0)
    v_xor_b32 v217, 1, v217
    v_pk_mul_f32 v[208:209], v[168:169], v[160:161]
    v_pk_mul_f32 v[210:211], v[170:171], v[162:163]
    v_pk_mul_f32 v[212:213], v[172:173], v[164:165]
    v_pk_mul_f32 v[214:215], v[174:175], v[166:167]
    v_or_b32 v216, v216, v217
    v_permlane32_swap_b32 v208, v210
    v_permlane32_swap_b32 v209, v211
    v_permlane32_swap_b32 v212, v214
    v_permlane32_swap_b32 v213, v215
    v_pk_add_f32 v[208:209], v[208:209], v[210:211]
    v_pk_add_f32 v[212:213], v[212:213], v[214:215]
    v_and_b32 v216, 0xff, v216
    v_cmp_ne_u32 vcc, 0, v216
    s_cbranch_vccnz RS7
OK8:
    v_permlane16_swap_b32 v208, v209
    v_permlane16_swap_b32 v212, v213
    v_add_f32 v208, v208, v209
    v_add_f32 v212, v212, v213
    s_nop 0
    v_add_f32_dpp v208, v208, v208 row_ror:8 row_mask:0xf bank_mask:0xf
    v_add_f32_dpp v212, v212, v212 row_ror:8 row_mask:0xf bank_mask:0xf
    s_nop 0
    v_add_f32_dpp v208, v208, v208 row_ror:4 row_mask:0xf bank_mask:0xf
    v_add_f32_dpp v212, v212, v212 row_ror:4 row_mask:0xf bank_mask:0xf
    v_cndmask_b32 v209, v208, v212, s[56:57]
    v_cvt_pk_bf16_f32 v208, v209, v209
    s_nop 1
    v_and_b32_dpp v176, v208, v248 quad_perm:[0,0,0,0] row_mask:0xf bank_mask:0xf
    v_and_b32_dpp v177, v208, v249 quad_perm:[0,0,0,0] row_mask:0xf bank_mask:0xf
    v_and_b32_dpp v178, v208, v250 quad_perm:[0,0,0,0] row_mask:0xf bank_mask:0xf
    v_and_b32_dpp v179, v208, v251 quad_perm:[0,0,0,0] row_mask:0xf bank_mask:0xf
    v_and_b32_dpp v180, v208, v248 quad_perm:[1,1,1,1] row_mask:0xf bank_mask:0xf
    v_and_b32_dpp v181, v208, v249 quad_perm:[1,1,1,1] row_mask:0xf bank_mask:0xf
    v_and_b32_dpp v182, v208, v250 quad_perm:[1,1,1,1] row_mask:0xf bank_mask:0xf
    v_and_b32_dpp v183, v208, v251 quad_perm:[1,1,1,1] row_mask:0xf bank_mask:0xf
    v_mfma_f32_16x16x32_bf16 v[216:219], v[176:179], v[144:147], 0
    v_and_b32_dpp v184, v208, v248 quad_perm:[2,2,2,2] row_mask:0xf bank_mask:0xf
    v_and_b32_dpp v185, v208, v249 quad_perm:[2,2,2,2] row_mask:0xf bank_mask:0xf
    v_and_b32_dpp v186, v208, v250 quad_perm:[2,2,2,2] row_mask:0xf bank_mask:0xf
    v_and_b32_dpp v187, v208, v251 quad_perm:[2,2,2,2] row_mask:0xf bank_mask:0xf
    v_mfma_f32_16x16x32_bf16 v[216:219], v[180:183], v[148:151], v[216:219]
    v_and_b32_dpp v188, v208, v248 quad_perm:[3,3,3,3] row_mask:0xf bank_mask:0xf
    v_and_b32_dpp v189, v208, v249 quad_perm:[3,3,3,3] row_mask:0xf bank_mask:0xf
    v_and_b32_dpp v190, v208, v250 quad_perm:[3,3,3,3] row_mask:0xf bank_mask:0xf
    v_and_b32_dpp v191, v208, v251 quad_perm:[3,3,3,3] row_mask:0xf bank_mask:0xf
    v_mfma_f32_16x16x32_bf16 v[216:219], v[184:187], v[152:155], v[216:219]
    s_nop 0
    v_mfma_f32_16x16x32_bf16 v[216:219], v[188:191], v[156:159], v[216:219]
    s_nop 7
    ds_write_b128 v12, v[216:219] offset:12288
    s_mov_b64 exec, 1
    ds_add_rtn_u32 v224, v253, v254 offset:2852
    s_mov_b64 exec, -1
    ds_read_b128 v[80:83], v10 offset:12288
    ds_read_b128 v[84:87], v10 offset:13312
    ds_read_b128 v[88:91], v10 offset:14336
    ds_read_b128 v[92:95], v10 offset:15360
    ds_read_b128 v[96:99], v10 offset:3072
    s_waitcnt lgkmcnt(5)
    v_readfirstlane_b32 s4, v224
    s_cmp_lg_u32 s4, 4
    s_cbranch_scc1 ATTEND
    s_waitcnt lgkmcnt(3)
    v_pk_add_f32 v[80:81], v[80:81], v[84:85]
    v_pk_add_f32 v[82:83], v[82:83], v[86:87]
    s_waitcnt lgkmcnt(1)
    v_pk_add_f32 v[88:89], v[88:89], v[92:93]
    v_pk_add_f32 v[90:91], v[90:91], v[94:95]
    s_waitcnt lgkmcnt(0)
    v_pk_add_f32 v[80:81], v[80:81], v[96:97]
    v_pk_add_f32 v[82:83], v[82:83], v[98:99]
    v_pk_add_f32 v[80:81], v[80:81], v[88:89]
    v_pk_add_f32 v[82:83], v[82:83], v[90:91]
    v_and_or_b32 v80, v80, s37, v228
    v_and_or_b32 v81, v81, s37, v229
    v_and_or_b32 v82, v82, s37, v230
    v_and_or_b32 v83, v83, s37, v231
    global_store_dwordx4 v11, v[80:83], s[30:31] sc1
    s_waitcnt vmcnt(0)
    ds_write_b32 v253, v254 offset:2856
ATTEND:
    s_endpgm
CS4:
    global_store_dwordx4 v252, v[232:235], s[30:31] sc1
    s_branch CS5
RS7:
    s_sub_u32 s40, s40, 1
    s_cbranch_scc0 OG6
    s_mov_b32 s40, 0
    s_branch OK8
AUX2:
PADB1:
    s_cbranch_execz HBBAR
    s_waitcnt vmcnt(0)
    v_lshlrev_b32 v80, 16, v208
    v_and_b32 v81, 0xffff0000, v208
    v_lshlrev_b32 v82, 16, v209
    v_and_b32 v83, 0xffff0000, v209
    v_lshlrev_b32 v84, 16, v210
    v_and_b32 v85, 0xffff0000, v210
    v_lshlrev_b32 v86, 16, v211
    v_and_b32 v87, 0xffff0000, v211
    v_lshlrev_b32 v88, 16, v212
    v_and_b32 v89, 0xffff0000, v212
    v_lshlrev_b32 v90, 16, v213
    v_and_b32 v91, 0xffff0000, v213
    v_lshlrev_b32 v92, 16, v214
    v_and_b32 v93, 0xffff0000, v214
    v_lshlrev_b32 v94, 16, v215
    v_and_b32 v95, 0xffff0000, v215
    v_pk_add_f32 v[236:237], v[80:81], v[82:83]
    v_pk_add_f32 v[236:237], v[236:237], v[84:85]
    v_pk_add_f32 v[236:237], v[236:237], v[86:87]
    v_pk_add_f32 v[236:237], v[236:237], v[88:89]
    v_pk_add_f32 v[236:237], v[236:237], v[90:91]
    v_pk_add_f32 v[236:237], v[236:237], v[92:93]
    v_pk_add_f32 v[236:237], v[236:237], v[94:95]
    v_add_f32 v236, v236, v237
    s_nop 1
    v_add_f32_dpp v236, v236, v236 row_ror:8 row_mask:0xf bank_mask:0xf
    s_nop 1
    v_add_f32_dpp v236, v236, v236 row_ror:4 row_mask:0xf bank_mask:0xf
    s_nop 1
    v_add_f32_dpp v236, v236, v236 row_ror:2 row_mask:0xf bank_mask:0xf
    s_nop 1
    v_add_f32_dpp v236, v236, v236 row_ror:1 row_mask:0xf bank_mask:0xf
    v_mov_b32 v237, v236
    s_nop 1
    v_permlane16_swap_b32 v236, v237
    v_add_f32 v236, v236, v237
    v_mul_f32 v236, 0x3b000000, v236
    v_pk_add_f32 v[208:209], v[80:81], v[236:237] op_sel_hi:[1,0] neg_lo:[0,1] neg_hi:[0,1]
    v_pk_add_f32 v[210:211], v[82:83], v[236:237] op_sel_hi:[1,0] neg_lo:[0,1] neg_hi:[0,1]
    v_pk_add_f32 v[212:213], v[84:85], v[236:237] op_sel_hi:[1,0] neg_lo:[0,1] neg_hi:[0,1]
    v_pk_add_f32 v[214:215], v[86:87], v[236:237] op_sel_hi:[1,0] neg_lo:[0,1] neg_hi:[0,1]
    v_pk_add_f32 v[216:217], v[88:89], v[236:237] op_sel_hi:[1,0] neg_lo:[0,1] neg_hi:[0,1]
    v_pk_add_f32 v[218:219], v[90:91], v[236:237] op_sel_hi:[1,0] neg_lo:[0,1] neg_hi:[0,1]
    v_pk_add_f32 v[220:221], v[92:93], v[236:237] op_sel_hi:[1,0] neg_lo:[0,1] neg_hi:[0,1]
    v_pk_add_f32 v[222:223], v[94:95], v[236:237] op_sel_hi:[1,0] neg_lo:[0,1] neg_hi:[0,1]
    v_pk_mul_f32 v[238:239], v[208:209], v[208:209]
    v_pk_fma_f32 v[238:239], v[210:211], v[210:211], v[238:239]
    v_pk_fma_f32 v[238:239], v[212:213], v[212:213], v[238:239]
    v_pk_fma_f32 v[238:239], v[214:215], v[214:215], v[238:239]
    v_pk_fma_f32 v[238:239], v[216:217], v[216:217], v[238:239]
    v_pk_fma_f32 v[238:239], v[218:219], v[218:219], v[238:239]
    v_pk_fma_f32 v[238:239], v[220:221], v[220:221], v[238:239]
    v_pk_fma_f32 v[238:239], v[222:223], v[222:223], v[238:239]
    v_add_f32 v238, v238, v239
    s_nop 1
    v_add_f32_dpp v238, v238, v238 row_ror:8 row_mask:0xf bank_mask:0xf
    s_nop 1
    v_add_f32_dpp v238, v238, v238 row_ror:4 row_mask:0xf bank_mask:0xf
    s_nop 1
    v_add_f32_dpp v238, v238, v238 row_ror:2 row_mask:0xf bank_mask:0xf
    s_nop 1
    v_add_f32_dpp v238, v238, v238 row_ror:1 row_mask:0xf bank_mask:0xf
    v_mov_b32 v239, v238
    s_nop 1
    v_permlane16_swap_b32 v238, v239
    v_add_f32 v238, v238, v239
    v_mul_f32 v238, 0x3b000000, v238
    v_cvt_pk_bf16_f32 v239, v236, v238
    v_lshlrev_b32 v236, 16, v239
    v_and_b32 v238, 0xffff0000, v239
    v_add_f32 v238, 0x3727c5ac, v238
    v_cvt_pk_bf16_f32 v238, v238, v238
    v_and_b32 v238, 0xffff0000, v238
    v_sqrt_f32 v238, v238
    v_pk_add_f32 v[80:81], v[80:81], v[236:237] op_sel_hi:[1,0] neg_lo:[0,1] neg_hi:[0,1]
    v_pk_add_f32 v[82:83], v[82:83], v[236:237] op_sel_hi:[1,0] neg_lo:[0,1] neg_hi:[0,1]
    v_pk_add_f32 v[84:85], v[84:85], v[236:237] op_sel_hi:[1,0] neg_lo:[0,1] neg_hi:[0,1]
    v_pk_add_f32 v[86:87], v[86:87], v[236:237] op_sel_hi:[1,0] neg_lo:[0,1] neg_hi:[0,1]
    v_pk_add_f32 v[88:89], v[88:89], v[236:237] op_sel_hi:[1,0] neg_lo:[0,1] neg_hi:[0,1]
    v_pk_add_f32 v[90:91], v[90:91], v[236:237] op_sel_hi:[1,0] neg_lo:[0,1] neg_hi:[0,1]
    v_pk_add_f32 v[92:93], v[92:93], v[236:237] op_sel_hi:[1,0] neg_lo:[0,1] neg_hi:[0,1]
    v_pk_add_f32 v[94:95], v[94:95], v[236:237] op_sel_hi:[1,0] neg_lo:[0,1] neg_hi:[0,1]
    v_cvt_pk_bf16_f32 v238, v238, v238
    v_and_b32 v238, 0xffff0000, v238
    v_rcp_f32 v238, v238
    v_cvt_pk_bf16_f32 v240, v80, v81
    v_lshlrev_b32 v80, 16, v240
    v_and_b32 v81, 0xffff0000, v240
    v_cvt_pk_bf16_f32 v240, v82, v83
    v_lshlrev_b32 v82, 16, v240
    v_and_b32 v83, 0xffff0000, v240
    v_cvt_pk_bf16_f32 v240, v84, v85
    v_lshlrev_b32 v84, 16, v240
    v_and_b32 v85, 0xffff0000, v240
    v_cvt_pk_bf16_f32 v240, v86, v87
    v_lshlrev_b32 v86, 16, v240
    v_and_b32 v87, 0xffff0000, v240
    v_cvt_pk_bf16_f32 v240, v88, v89
    v_lshlrev_b32 v88, 16, v240
    v_and_b32 v89, 0xffff0000, v240
    v_cvt_pk_bf16_f32 v240, v90, v91
    v_lshlrev_b32 v90, 16, v240
    v_and_b32 v91, 0xffff0000, v240
    v_cvt_pk_bf16_f32 v240, v92, v93
    v_lshlrev_b32 v92, 16, v240
    v_and_b32 v93, 0xffff0000, v240
    v_cvt_pk_bf16_f32 v240, v94, v95
    v_lshlrev_b32 v94, 16, v240
    v_and_b32 v95, 0xffff0000, v240
    v_pk_mul_f32 v[80:81], v[80:81], v[238:239] op_sel_hi:[1,0]
    v_cvt_pk_bf16_f32 v208, v80, v81
    ds_bpermute_b32 v104, v8, v208
    v_pk_mul_f32 v[82:83], v[82:83], v[238:239] op_sel_hi:[1,0]
    v_cvt_pk_bf16_f32 v209, v82, v83
    ds_bpermute_b32 v105, v8, v209
    v_pk_mul_f32 v[84:85], v[84:85], v[238:239] op_sel_hi:[1,0]
    v_cvt_pk_bf16_f32 v210, v84, v85
    ds_bpermute_b32 v106, v8, v210
    v_pk_mul_f32 v[86:87], v[86:87], v[238:239] op_sel_hi:[1,0]
    v_cvt_pk_bf16_f32 v211, v86, v87
    ds_bpermute_b32 v107, v8, v211
    v_pk_mul_f32 v[88:89], v[88:89], v[238:239] op_sel_hi:[1,0]
    v_cvt_pk_bf16_f32 v212, v88, v89
    ds_bpermute_b32 v108, v8, v212
    v_pk_mul_f32 v[90:91], v[90:91], v[238:239] op_sel_hi:[1,0]
    v_cvt_pk_bf16_f32 v213, v90, v91
    ds_bpermute_b32 v109, v8, v213
    v_pk_mul_f32 v[92:93], v[92:93], v[238:239] op_sel_hi:[1,0]
    v_cvt_pk_bf16_f32 v214, v92, v93
    ds_bpermute_b32 v110, v8, v214
    v_pk_mul_f32 v[94:95], v[94:95], v[238:239] op_sel_hi:[1,0]
    v_cvt_pk_bf16_f32 v215, v94, v95
    ds_bpermute_b32 v111, v8, v215
    s_waitcnt lgkmcnt(0)
    v_perm_b32 v144, v104, v104, v96
    v_perm_b32 v145, v104, v104, v97
    v_perm_b32 v146, v104, v104, v98
    v_perm_b32 v147, v104, v104, v99
    v_perm_b32 v148, v104, v104, v100
    v_perm_b32 v149, v104, v104, v101
    v_perm_b32 v150, v104, v104, v102
    v_perm_b32 v151, v104, v104, v103
    v_perm_b32 v152, v105, v105, v96
PADB0:
    s_cbranch_execz PADB1
    v_perm_b32 v153, v105, v105, v97
    v_perm_b32 v154, v105, v105, v98
    v_perm_b32 v155, v105, v105, v99
    v_perm_b32 v156, v105, v105, v100
    v_perm_b32 v157, v105, v105, v101
    v_perm_b32 v158, v105, v105, v102
    v_perm_b32 v159, v105, v105, v103
    v_perm_b32 v160, v106, v106, v96
    v_perm_b32 v161, v106, v106, v97
    v_perm_b32 v162, v106, v106, v98
    v_perm_b32 v163, v106, v106, v99
    v_perm_b32 v164, v106, v106, v100
    v_perm_b32 v165, v106, v106, v101
    v_perm_b32 v166, v106, v106, v102
    v_perm_b32 v167, v106, v106, v103
    v_perm_b32 v168, v107, v107, v96
    v_perm_b32 v169, v107, v107, v97
    v_perm_b32 v170, v107, v107, v98
    v_perm_b32 v171, v107, v107, v99
    v_perm_b32 v172, v107, v107, v100
    v_perm_b32 v173, v107, v107, v101
    v_perm_b32 v174, v107, v107, v102
    v_perm_b32 v175, v107, v107, v103
    v_perm_b32 v176, v108, v108, v96
    v_perm_b32 v177, v108, v108, v97
    v_perm_b32 v178, v108, v108, v98
    v_perm_b32 v179, v108, v108, v99
    v_perm_b32 v180, v108, v108, v100
    v_perm_b32 v181, v108, v108, v101
    v_perm_b32 v182, v108, v108, v102
    v_perm_b32 v183, v108, v108, v103
    v_perm_b32 v184, v109, v109, v96
    v_perm_b32 v185, v109, v109, v97
    v_perm_b32 v186, v109, v109, v98
    v_perm_b32 v187, v109, v109, v99
    v_perm_b32 v188, v109, v109, v100
    v_perm_b32 v189, v109, v109, v101
    v_perm_b32 v190, v109, v109, v102
    v_perm_b32 v191, v109, v109, v103
    v_perm_b32 v192, v110, v110, v96
    v_perm_b32 v193, v110, v110, v97
    v_perm_b32 v194, v110, v110, v98
    v_perm_b32 v195, v110, v110, v99
    v_perm_b32 v196, v110, v110, v100
    v_perm_b32 v197, v110, v110, v101
    v_perm_b32 v198, v110, v110, v102
    v_perm_b32 v199, v110, v110, v103
    v_perm_b32 v200, v111, v111, v96
    v_perm_b32 v201, v111, v111, v97
    v_perm_b32 v202, v111, v111, v98
    v_perm_b32 v203, v111, v111, v99
    v_perm_b32 v204, v111, v111, v100
    v_perm_b32 v205, v111, v111, v101
    v_perm_b32 v206, v111, v111, v102
    v_perm_b32 v207, v111, v111, v103
    s_add_u32 s36, s38, 1
    s_and_b32 s84, s36, 0xff
    s_bfe_u32 s4, s36, 0x80008
    s_xor_b32 s85, s4, s84
    s_bfe_u32 s4, s36, 0x80010
    s_xor_b32 s86, s4, s84
    s_bfe_u32 s4, s36, 0x80018
    s_xor_b32 s87, s4, s84
    v_mov_b32 v248, s84
    v_mov_b32 v249, s85
    v_mov_b32 v250, s86
    v_mov_b32 v251, s87
    s_bfe_u32 s4, s50, 65536
    s_lshl_b32 s4, s4, 8
    s_or_b32 s76, s4, s84
    v_mov_b32 v244, s76
    s_bfe_u32 s4, s50, 65537
    s_lshl_b32 s4, s4, 8
    s_or_b32 s77, s4, s85
    v_mov_b32 v245, s77
    s_bfe_u32 s4, s50, 65538
    s_lshl_b32 s4, s4, 8
    s_or_b32 s78, s4, s86
    v_mov_b32 v246, s78
    s_bfe_u32 s4, s50, 65539
    s_lshl_b32 s4, s4, 8
    s_or_b32 s79, s4, s87
    v_mov_b32 v247, s79
AW9:
    ds_read_b32 v240, v253 offset:2816
    s_waitcnt lgkmcnt(0)
    v_cmp_gt_u32 vcc, 4, v240
    s_cbranch_vccnz AW9
    ds_read_b128 v[16:19], v7 offset:0
    ds_read_b128 v[20:23], v7 offset:1024
    ds_read_b128 v[24:27], v7 offset:2048
    ds_read_b128 v[28:31], v7 offset:3072
    ds_read_b128 v[32:35], v7 offset:4096
    ds_read_b128 v[36:39], v7 offset:5120
    ds_read_b128 v[40:43], v7 offset:6144
    ds_read_b128 v[44:47], v7 offset:7168
    ds_read_b128 v[48:51], v7 offset:8192
    ds_read_b128 v[52:55], v7 offset:9216
    ds_read_b128 v[56:59], v7 offset:10240
    ds_read_b128 v[60:63], v7 offset:11264
    ds_read_b128 v[64:67], v7 offset:12288
    ds_read_b128 v[68:71], v7 offset:13312
    ds_read_b128 v[72:75], v7 offset:14336
    ds_read_b128 v[76:79], v7 offset:15360
    s_waitcnt lgkmcnt(14)
    v_mfma_f32_16x16x32_bf16 v[228:231], v[144:147], v[16:19], 0
    s_waitcnt lgkmcnt(14)
    v_mfma_f32_16x16x32_bf16 v[228:231], v[148:151], v[20:23], v[228:231]
    s_waitcnt lgkmcnt(13)
    v_mfma_f32_16x16x32_bf16 v[228:231], v[152:155], v[24:27], v[228:231]
    s_waitcnt lgkmcnt(12)
    v_mfma_f32_16x16x32_bf16 v[228:231], v[156:159], v[28:31], v[228:231]
    s_waitcnt lgkmcnt(11)
    v_mfma_f32_16x16x32_bf16 v[228:231], v[160:163], v[32:35], v[228:231]
    s_waitcnt lgkmcnt(10)
    v_mfma_f32_16x16x32_bf16 v[228:231], v[164:167], v[36:39], v[228:231]
    s_waitcnt lgkmcnt(9)
    v_mfma_f32_16x16x32_bf16 v[228:231], v[168:171], v[40:43], v[228:231]
    s_waitcnt lgkmcnt(8)
    v_mfma_f32_16x16x32_bf16 v[228:231], v[172:175], v[44:47], v[228:231]
    s_waitcnt lgkmcnt(7)
    v_mfma_f32_16x16x32_bf16 v[228:231], v[176:179], v[48:51], v[228:231]
    s_waitcnt lgkmcnt(6)
    v_mfma_f32_16x16x32_bf16 v[228:231], v[180:183], v[52:55], v[228:231]
    s_waitcnt lgkmcnt(5)
    v_mfma_f32_16x16x32_bf16 v[228:231], v[184:187], v[56:59], v[228:231]
    s_waitcnt lgkmcnt(4)
    v_mfma_f32_16x16x32_bf16 v[228:231], v[188:191], v[60:63], v[228:231]
    s_waitcnt lgkmcnt(3)
    v_mfma_f32_16x16x32_bf16 v[228:231], v[192:195], v[64:67], v[228:231]
    s_waitcnt lgkmcnt(2)
    v_mfma_f32_16x16x32_bf16 v[228:231], v[196:199], v[68:71], v[228:231]
    s_waitcnt lgkmcnt(1)
    v_mfma_f32_16x16x32_bf16 v[228:231], v[200:203], v[72:75], v[228:231]
    s_waitcnt lgkmcnt(0)
    v_mfma_f32_16x16x32_bf16 v[228:231], v[204:207], v[76:79], v[228:231]
    s_mov_b32 s56, 0xfffffe00
    s_mov_b32 s49, 0
    s_mov_b32 s55, 0
    s_nop 4
    v_add_u32 v228, 0x100, v228
    v_add_u32 v229, 0x100, v229
    v_add_u32 v230, 0x100, v230
    v_add_u32 v231, 0x100, v231
    v_and_or_b32 v228, v228, s56, v244
    v_and_or_b32 v229, v229, s56, v245
    v_and_or_b32 v230, v230, s56, v246
    v_and_or_b32 v231, v231, s56, v247
    global_store_dwordx4 v14, v[228:231], s[30:31]
QAPUB:
    s_and_b32 s4, s33, 1
    s_lshl_b32 s4, s4, 5
    s_lshl_b32 s5, s32, 2
    s_add_u32 s4, s4, s5
    s_lshl_b32 s4, s4, 12
    s_add_u32 s4, s4, 1052672
    v_lshlrev_b32 v9, 4, v2
    v_add_u32 v9, s4, v9
    v_and_b32 v11, 31, v2
    v_lshlrev_b32 v8, 9, v11
    v_add_u32 v8, s4, v8
    s_movk_i32 s42, 0x1000
    s_lshl_b32 s46, s32, 3
    s_add_u32 s46, s46, s34
    s_and_b32 s4, s45, 1
    s_lshl_b32 s5, s4, 3
    s_add_u32 s5, s5, s34
    s_mul_i32 s5, s5, 14336
    s_lshr_b32 s4, s35, 1
    s_lshl_b32 s4, s4, 9
    s_add_u32 s5, s5, s4
    s_add_u32 s5, s5, 294912
    v_mul_u32_u24 v15, 7168, v13
    v_add3_u32 v15, v15, v12, s5
AW14:
    ds_read_b32 v240, v253 offset:2820
    s_waitcnt lgkmcnt(0)
    v_cmp_gt_u32 vcc, 4, v240
    s_cbranch_vccnz AW14
    s_branch QG11
QPROBE10:
    s_add_u32 s49, s49, 1
    s_cmp_lt_u32 s49, 12
PADC4:
    s_cbranch_execz END
    s_cbranch_scc1 PA12
    v_xor_b32 v8, 1048576, v8
    v_xor_b32 v9, 1048576, v9
    s_cmp_lg_u32 s55, 0
    s_cbranch_scc1 PA12
    s_mov_b32 s55, 1
    v_subrev_u32 v1, 1048576, v14
    global_store_dwordx4 v1, v[228:231], s[30:31] sc1
PA12:
    s_cmp_eq_u32 s49, 1
    s_cbranch_scc1 QG11
    global_load_dwordx4 v[236:239], v8, s[30:31] sc1 nt
    s_waitcnt vmcnt(0)
    v_xor_b32 v236, s84, v236
    v_xor_b32 v237, s85, v237
    v_xor_b32 v238, s86, v238
    v_xor_b32 v239, s87, v239
    v_or3_b32 v240, v236, v237, v238
    v_or_b32 v240, v240, v239
    v_and_b32 v240, 0xff, v240
    v_cmp_ne_u32 vcc, 0, v240
    s_cbranch_vccnz RS15
OK16:
QG11:
    v_mov_b32 v10, v9
    global_load_dwordx4 v[16:19], v10, s[30:31] offset:0 sc1 nt
    global_load_dwordx4 v[20:23], v10, s[30:31] offset:1024 sc1 nt
    global_load_dwordx4 v[24:27], v10, s[30:31] offset:2048 sc1 nt
    global_load_dwordx4 v[28:31], v10, s[30:31] offset:3072 sc1 nt
    v_add_u32 v10, s42, v10
    global_load_dwordx4 v[32:35], v10, s[30:31] offset:0 sc1 nt
    global_load_dwordx4 v[36:39], v10, s[30:31] offset:1024 sc1 nt
    global_load_dwordx4 v[40:43], v10, s[30:31] offset:2048 sc1 nt
    global_load_dwordx4 v[44:47], v10, s[30:31] offset:3072 sc1 nt
    v_add_u32 v10, s42, v10
    global_load_dwordx4 v[48:51], v10, s[30:31] offset:0 sc1 nt
    global_load_dwordx4 v[52:55], v10, s[30:31] offset:1024 sc1 nt
    global_load_dwordx4 v[56:59], v10, s[30:31] offset:2048 sc1 nt
    global_load_dwordx4 v[60:63], v10, s[30:31] offset:3072 sc1 nt
    v_add_u32 v10, s42, v10
    global_load_dwordx4 v[64:67], v10, s[30:31] offset:0 sc1 nt
    global_load_dwordx4 v[68:71], v10, s[30:31] offset:1024 sc1 nt
    global_load_dwordx4 v[72:75], v10, s[30:31] offset:2048 sc1 nt
    global_load_dwordx4 v[76:79], v10, s[30:31] offset:3072 sc1 nt
    s_waitcnt vmcnt(0)
    v_xor_b32 v16, s76, v16
    v_xor_b32 v17, s77, v17
    v_xor_b32 v18, s78, v18
    v_xor_b32 v19, s79, v19
    v_xor_b32 v20, s76, v20
    v_xor_b32 v21, s77, v21
    v_xor_b32 v22, s78, v22
    v_xor_b32 v23, s79, v23
    v_xor_b32 v24, s76, v24
    v_xor_b32 v25, s77, v25
    v_xor_b32 v26, s78, v26
    v_xor_b32 v27, s79, v27
    v_xor_b32 v28, s76, v28
    v_xor_b32 v29, s77, v29
    v_xor_b32 v30, s78, v30
    v_xor_b32 v31, s79, v31
    v_xor_b32 v32, s76, v32
    v_xor_b32 v33, s77, v33
    v_xor_b32 v34, s78, v34
    v_xor_b32 v35, s79, v35
    v_xor_b32 v36, s76, v36
    v_xor_b32 v37, s77, v37
    v_xor_b32 v38, s78, v38
    v_xor_b32 v39, s79, v39
    v_xor_b32 v40, s76, v40
    v_xor_b32 v41, s77, v41
    v_xor_b32 v42, s78, v42
    v_xor_b32 v43, s79, v43
    v_xor_b32 v44, s76, v44
    v_xor_b32 v45, s77, v45
    v_xor_b32 v46, s78, v46
    v_xor_b32 v47, s79, v47
    v_xor_b32 v48, s76, v48
    v_xor_b32 v49, s77, v49
    v_xor_b32 v50, s78, v50
    v_xor_b32 v51, s79, v51
    v_xor_b32 v52, s76, v52
    v_xor_b32 v53, s77, v53
    v_xor_b32 v54, s78, v54
    v_xor_b32 v55, s79, v55
    v_xor_b32 v56, s76, v56
    v_xor_b32 v57, s77, v57
    v_xor_b32 v58, s78, v58
    v_xor_b32 v59, s79, v59
    v_xor_b32 v60, s76, v60
    v_xor_b32 v61, s77, v61
    v_xor_b32 v62, s78, v62
    v_xor_b32 v63, s79, v63
    v_xor_b32 v64, s76, v64
    v_xor_b32 v65, s77, v65
    v_xor_b32 v66, s78, v66
    v_xor_b32 v67, s79, v67
    v_xor_b32 v68, s76, v68
    v_xor_b32 v69, s77, v69
    v_xor_b32 v70, s78, v70
    v_xor_b32 v71, s79, v71
    v_xor_b32 v72, s76, v72
    v_xor_b32 v73, s77, v73
    v_xor_b32 v74, s78, v74
    v_xor_b32 v75, s79, v75
    v_xor_b32 v76, s76, v76
    v_xor_b32 v77, s77, v77
    v_xor_b32 v78, s78, v78
    v_xor_b32 v79, s79, v79
    v_or3_b32 v240, v16, v17, v18
    v_or3_b32 v240, v240, v19, v20
    v_or3_b32 v240, v240, v21, v22
    v_or3_b32 v240, v240, v23, v24
    v_or3_b32 v240, v240, v25, v26
    v_or3_b32 v240, v240, v27, v28
    v_or3_b32 v240, v240, v29, v30
    v_or3_b32 v240, v240, v31, v32
    v_or3_b32 v240, v240, v33, v34
    v_or3_b32 v240, v240, v35, v36
    v_or3_b32 v240, v240, v37, v38
    v_or3_b32 v240, v240, v39, v40
    v_or3_b32 v240, v240, v41, v42
    v_or3_b32 v240, v240, v43, v44
    v_or3_b32 v240, v240, v45, v46
    v_or3_b32 v240, v240, v47, v48
    v_or3_b32 v240, v240, v49, v50
    v_or3_b32 v240, v240, v51, v52
    v_or3_b32 v240, v240, v53, v54
    v_or3_b32 v240, v240, v55, v56
    v_or3_b32 v240, v240, v57, v58
    v_or3_b32 v240, v240, v59, v60
    v_or3_b32 v240, v240, v61, v62
    v_or3_b32 v240, v240, v63, v64
    v_or3_b32 v240, v240, v65, v66
    v_or3_b32 v240, v240, v67, v68
    v_or3_b32 v240, v240, v69, v70
    v_or3_b32 v240, v240, v71, v72
    v_or3_b32 v240, v240, v73, v74
    v_or3_b32 v240, v240, v75, v76
    v_or3_b32 v240, v240, v77, v78
    v_or_b32 v240, v240, v79
    v_and_b32 v241, 0xff, v240
    v_cmp_ne_u32 vcc, 0, v241
    s_cbranch_vccz OKQ17
    s_sub_u32 s40, s40, 1
    s_cbranch_scc0 QPROBE10
    s_mov_b32 s40, 0
OKQ17:
    v_and_b32 v241, 0x100, v240
    v_cmp_ne_u32 vcc, 0, v241
    s_mov_b32 s51, 1
    s_cbranch_vccz NOB13
    s_mov_b32 s51, 0
    v_and_b32 v16, s56, v16
    v_and_b32 v17, s56, v17
    v_and_b32 v18, s56, v18
    v_and_b32 v19, s56, v19
    v_and_b32 v20, s56, v20
    v_and_b32 v21, s56, v21
    v_and_b32 v22, s56, v22
    v_and_b32 v23, s56, v23
    v_and_b32 v24, s56, v24
    v_and_b32 v25, s56, v25
    v_and_b32 v26, s56, v26
    v_and_b32 v27, s56, v27
    v_and_b32 v28, s56, v28
    v_and_b32 v29, s56, v29
    v_and_b32 v30, s56, v30
    v_and_b32 v31, s56, v31
    v_and_b32 v32, s56, v32
    v_and_b32 v33, s56, v33
    v_and_b32 v34, s56, v34
    v_and_b32 v35, s56, v35
    v_and_b32 v36, s56, v36
    v_and_b32 v37, s56, v37
    v_and_b32 v38, s56, v38
    v_and_b32 v39, s56, v39
    v_and_b32 v40, s56, v40
    v_and_b32 v41, s56, v41
    v_and_b32 v42, s56, v42
    v_and_b32 v43, s56, v43
    v_and_b32 v44, s56, v44
    v_and_b32 v45, s56, v45
    v_and_b32 v46, s56, v46
    v_and_b32 v47, s56, v47
    v_and_b32 v48, s56, v48
    v_and_b32 v49, s56, v49
    v_and_b32 v50, s56, v50
    v_and_b32 v51, s56, v51
    v_and_b32 v52, s56, v52
    v_and_b32 v53, s56, v53
    v_and_b32 v54, s56, v54
    v_and_b32 v55, s56, v55
    v_and_b32 v56, s56, v56
    v_and_b32 v57, s56, v57
    v_and_b32 v58, s56, v58
    v_and_b32 v59, s56, v59
    v_and_b32 v60, s56, v60
PADC3:
    s_cbranch_execz PADC4
    v_and_b32 v61, s56, v61
    v_and_b32 v62, s56, v62
    v_and_b32 v63, s56, v63
    v_and_b32 v64, s56, v64
    v_and_b32 v65, s56, v65
    v_and_b32 v66, s56, v66
    v_and_b32 v67, s56, v67
    v_and_b32 v68, s56, v68
    v_and_b32 v69, s56, v69
    v_and_b32 v70, s56, v70
    v_and_b32 v71, s56, v71
    v_and_b32 v72, s56, v72
    v_and_b32 v73, s56, v73
    v_and_b32 v74, s56, v74
    v_and_b32 v75, s56, v75
    v_and_b32 v76, s56, v76
    v_and_b32 v77, s56, v77
    v_and_b32 v78, s56, v78
    v_and_b32 v79, s56, v79
    s_cmp_lg_u32 s55, 0
    s_cbranch_scc1 NOB13
    s_mov_b32 s55, 1
    v_subrev_u32 v1, 1048576, v14
    global_store_dwordx4 v1, v[228:231], s[30:31] sc1
NOB13:
    v_pk_add_f32 v[16:17], v[16:17], v[20:21]
    v_pk_add_f32 v[24:25], v[24:25], v[28:29]
    v_pk_add_f32 v[16:17], v[16:17], v[24:25]
    v_pk_add_f32 v[18:19], v[18:19], v[22:23]
    v_pk_add_f32 v[26:27], v[26:27], v[30:31]
    v_pk_add_f32 v[18:19], v[18:19], v[26:27]
    v_pk_add_f32 v[32:33], v[32:33], v[36:37]
    v_pk_add_f32 v[40:41], v[40:41], v[44:45]
    v_pk_add_f32 v[32:33], v[32:33], v[40:41]
    v_pk_add_f32 v[34:35], v[34:35], v[38:39]
    v_pk_add_f32 v[42:43], v[42:43], v[46:47]
    v_pk_add_f32 v[34:35], v[34:35], v[42:43]
    v_pk_add_f32 v[48:49], v[48:49], v[52:53]
    v_pk_add_f32 v[56:57], v[56:57], v[60:61]
    v_pk_add_f32 v[48:49], v[48:49], v[56:57]
    v_pk_add_f32 v[50:51], v[50:51], v[54:55]
    v_pk_add_f32 v[58:59], v[58:59], v[62:63]
    v_pk_add_f32 v[50:51], v[50:51], v[58:59]
    v_pk_add_f32 v[64:65], v[64:65], v[68:69]
    v_pk_add_f32 v[72:73], v[72:73], v[76:77]
    v_pk_add_f32 v[64:65], v[64:65], v[72:73]
    v_pk_add_f32 v[66:67], v[66:67], v[70:71]
    v_pk_add_f32 v[74:75], v[74:75], v[78:79]
    v_pk_add_f32 v[66:67], v[66:67], v[74:75]
    v_lshrrev_b32 v10, 5, v2
    v_mul_u32_u24 v10, 320, v10
    v_lshl_add_u32 v10, v11, 3, v10
    s_lshl_b32 s5, s51, 1
    s_or_b32 s5, s5, 1
    v_mov_b32 v236, s5
    v_permlane32_swap_b32 v16, v32
    v_permlane32_swap_b32 v17, v33
    v_permlane32_swap_b32 v18, v34
    v_permlane32_swap_b32 v19, v35
    v_pk_add_f32 v[16:17], v[16:17], v[32:33]
    v_pk_add_f32 v[18:19], v[18:19], v[34:35]
    v_cvt_pk_bf16_f32 v16, v16, v17
    v_cvt_pk_bf16_f32 v17, v18, v19
    ds_write_b64 v10, v[16:17] offset:0
    v_permlane32_swap_b32 v48, v64
    v_permlane32_swap_b32 v49, v65
    v_permlane32_swap_b32 v50, v66
    v_permlane32_swap_b32 v51, v67
    v_pk_add_f32 v[48:49], v[48:49], v[64:65]
    v_pk_add_f32 v[50:51], v[50:51], v[66:67]
    v_cvt_pk_bf16_f32 v48, v48, v49
    v_cvt_pk_bf16_f32 v49, v50, v51
    ds_write_b64 v10, v[48:49] offset:640
    ds_write_b32 v253, v236 offset:2828
    s_cmp_eq_u32 s32, 7
    s_cbranch_scc1 GUDONE
AW18:
    ds_read_b32 v240, v253 offset:2824
    s_waitcnt lgkmcnt(0)
    v_cmp_gt_u32 vcc, 4, v240
    s_cbranch_vccnz AW18
    ds_read_b128 v[80:83], v7 offset:16384
    ds_read_b128 v[84:87], v7 offset:17408
    ds_read_b128 v[88:91], v7 offset:18432
    ds_read_b128 v[92:95], v7 offset:19456
    ds_read_b128 v[96:99], v7 offset:20480
    ds_read_b128 v[100:103], v7 offset:21504
    ds_read_b128 v[104:107], v7 offset:22528
    ds_read_b128 v[108:111], v7 offset:23552
    ds_read_b128 v[112:115], v7 offset:24576
    ds_read_b128 v[116:119], v7 offset:25600
    ds_read_b128 v[120:123], v7 offset:26624
    ds_read_b128 v[124:127], v7 offset:27648
    ds_read_b128 v[128:131], v7 offset:28672
    ds_read_b128 v[132:135], v7 offset:29696
    ds_read_b128 v[136:139], v7 offset:30720
    ds_read_b128 v[140:143], v7 offset:31744
    s_waitcnt lgkmcnt(14)
    v_mfma_f32_16x16x32_bf16 v[232:235], v[144:147], v[80:83], 0
    s_waitcnt lgkmcnt(14)
    v_mfma_f32_16x16x32_bf16 v[232:235], v[148:151], v[84:87], v[232:235]
    s_waitcnt lgkmcnt(13)
    v_mfma_f32_16x16x32_bf16 v[232:235], v[152:155], v[88:91], v[232:235]
    s_waitcnt lgkmcnt(12)
    v_mfma_f32_16x16x32_bf16 v[232:235], v[156:159], v[92:95], v[232:235]
    s_waitcnt lgkmcnt(11)
    v_mfma_f32_16x16x32_bf16 v[232:235], v[160:163], v[96:99], v[232:235]
    s_waitcnt lgkmcnt(10)
    v_mfma_f32_16x16x32_bf16 v[232:235], v[164:167], v[100:103], v[232:235]
    s_waitcnt lgkmcnt(9)
    v_mfma_f32_16x16x32_bf16 v[232:235], v[168:171], v[104:107], v[232:235]
    s_waitcnt lgkmcnt(8)
    v_mfma_f32_16x16x32_bf16 v[232:235], v[172:175], v[108:111], v[232:235]
    s_waitcnt lgkmcnt(7)
    v_mfma_f32_16x16x32_bf16 v[232:235], v[176:179], v[112:115], v[232:235]
    s_waitcnt lgkmcnt(6)
    v_mfma_f32_16x16x32_bf16 v[232:235], v[180:183], v[116:119], v[232:235]
    s_waitcnt lgkmcnt(5)
    v_mfma_f32_16x16x32_bf16 v[232:235], v[184:187], v[120:123], v[232:235]
    s_waitcnt lgkmcnt(4)
    v_mfma_f32_16x16x32_bf16 v[232:235], v[188:191], v[124:127], v[232:235]
    s_waitcnt lgkmcnt(3)
    v_mfma_f32_16x16x32_bf16 v[232:235], v[192:195], v[128:131], v[232:235]
    s_waitcnt lgkmcnt(2)
    v_mfma_f32_16x16x32_bf16 v[232:235], v[196:199], v[132:135], v[232:235]
    s_waitcnt lgkmcnt(1)
    v_mfma_f32_16x16x32_bf16 v[232:235], v[200:203], v[136:139], v[232:235]
    s_waitcnt lgkmcnt(0)
    v_mfma_f32_16x16x32_bf16 v[232:235], v[204:207], v[140:143], v[232:235]
    s_nop 7
    v_add_u32 v232, 0x80, v232
    v_add_u32 v233, 0x80, v233
    v_add_u32 v234, 0x80, v234
    v_add_u32 v235, 0x80, v235
    v_and_or_b32 v232, v232, s37, v248
    v_and_or_b32 v233, v233, s37, v249
    v_and_or_b32 v234, v234, s37, v250
    v_and_or_b32 v235, v235, s37, v251
    s_cmp_eq_u32 s51, 0
    s_cbranch_scc1 CS19
    global_store_dwordx4 v15, v[232:235], s[30:31]
CS20:
GUDONE:
    s_lshl_b32 s4, s32, 10
    s_add_u32 s4, s4, 1343488
    v_lshlrev_b32 v10, 5, v11
    v_add_u32 v10, s4, v10
    s_lshl_b32 s4, s46, 7
    s_add_u32 s4, s4, 294912
    v_and_b32 v1, 7, v2
    v_lshrrev_b32 v14, 3, v2
    v_mul_u32_u24 v14, 14336, v14
    v_lshl_add_u32 v14, v1, 4, v14
    v_add_u32 v14, s4, v14
    v_add_u32 v15, 7168, v14
    v_add_u32 v6, 114688, v14
    v_add_u32 v7, 121856, v14
    s_lshl_b32 s4, s46, 15
    s_lshl_b32 s5, s45, 8
    s_add_u32 s4, s4, s5
    v_lshlrev_b32 v8, 10, v4
    v_lshl_add_u32 v8, v3, 4, v8
    v_add_u32 v8, s4, v8
    s_and_b32 s4, s33, 1
    s_lshl_b32 s5, s32, 1
PADC2:
    s_cbranch_execz PADC3
    s_add_u32 s4, s4, s5
    s_lshl_b32 s4, s4, 4
    s_lshr_b32 s5, s33, 1
    s_add_u32 s4, s4, s5
    s_lshl_b32 s4, s4, 5
    s_add_u32 s4, s4, 1343488
    v_lshlrev_b32 v9, 4, v2
    v_add_u32 v9, s4, v9
    s_lshl_b32 s4, s45, 6
    s_add_u32 s4, s4, s46
    s_lshl_b32 s4, s4, 10
    s_add_u32 s4, s4, 1376256
    v_lshl_add_u32 v12, v13, 9, v12
    v_add_u32 v12, s4, v12
    s_mov_b32 s43, 0x3fb8aa3b
    v_cmp_eq_u32 s[48:49], 0, v2
    v_lshlrev_b32 v11, 4, v11
    s_lshl4_add_u32 s57, s32, s33
    s_cmp_ge_u32 s33, 16
    s_cselect_b32 s57, 64, s57
    s_lshr_b32 s4, s57, 4
    s_and_b32 s4, s4, 3
    s_lshl_b32 s5, s4, 16
    s_and_b32 s35, s57, 15
    s_lshl_b32 s35, s35, 6
    s_add_u32 s5, s5, s35
    s_add_u32 s5, s5, 1376256
    v_and_b32 v21, 3, v2
    v_lshrrev_b32 v22, 2, v2
    v_lshlrev_b32 v22, 10, v22
    v_lshl_add_u32 v22, v21, 4, v22
    v_add_u32 v16, s5, v22
    v_add_u32 v17, 0x4000, v16
    v_add_u32 v18, 0x8000, v16
    v_add_u32 v19, 0xc000, v16
    s_lshl_b32 s4, s4, 8
    s_bfe_u32 s5, s57, 0x10003
    s_lshl_b32 s5, s5, 10
    s_add_u32 s4, s4, s5
    s_and_b32 s5, s57, 7
    s_lshl_b32 s5, s5, 5
    s_add_u32 s4, s4, s5
    v_lshl_add_u32 v13, v21, 2, v4
    v_lshlrev_b32 v13, 1, v13
    v_add_u32 v13, s4, v13
    global_load_ushort v20, v13, s[8:9]
    v_lshlrev_b32 v21, 4, v2
    v_lshlrev_b32 v22, 6, v4
    v_lshl_add_u32 v22, v1, 2, v22
    v_add_u32 v22, 2048, v22
    v_lshrrev_b32 v23, 3, v3
    v_lshlrev_b32 v23, 7, v23
    v_lshl_add_u32 v23, v4, 5, v23
AW21:
    ds_read_b32 v240, v253 offset:2836
    s_waitcnt lgkmcnt(0)
    v_cmp_gt_u32 vcc, 4, v240
    s_cbranch_vccnz AW21
    ds_read_b128 v[236:239], v253 offset:1792
    ds_read_b128 v[208:211], v253 offset:1808
    ds_read_b128 v[212:215], v253 offset:1824
    ds_read_b128 v[216:219], v253 offset:1840
    ds_read_b128 v[220:223], v253 offset:1856
    s_waitcnt lgkmcnt(0)
    v_pk_add_f32 v[208:209], v[208:209], v[212:213]
    v_pk_add_f32 v[210:211], v[210:211], v[214:215]
    v_pk_add_f32 v[216:217], v[216:217], v[220:221]
    v_pk_add_f32 v[218:219], v[218:219], v[222:223]
    v_pk_add_f32 v[208:209], v[208:209], v[216:217]
    v_pk_add_f32 v[210:211], v[210:211], v[218:219]
    v_cndmask_b32 v208, v208, v236, s[48:49]
    v_cndmask_b32 v209, v209, v237, s[48:49]
    v_cndmask_b32 v210, v210, v238, s[48:49]
    v_cndmask_b32 v211, v211, v239, s[48:49]
    v_and_or_b32 v208, v208, s37, v248
    v_and_or_b32 v209, v209, s37, v249
    v_and_or_b32 v210, v210, s37, v250
    v_and_or_b32 v211, v211, s37, v251
    s_mov_b64 exec, 3
    s_cmp_eq_u32 s51, 0
    s_cbranch_scc1 CS22
    global_store_dwordx4 v9, v[208:211], s[30:31]
CS23:
    s_mov_b64 exec, -1
    v_mov_b32 v232, 0
    v_mov_b32 v233, 0
    v_mov_b32 v234, 0
    v_mov_b32 v235, 0
    s_mov_b32 s58, 0
    s_cmp_eq_u32 s32, 7
    s_cbranch_scc1 NOH1
    global_load_dwordx4 v[80:83], v14, s[30:31] sc1 nt
    global_load_dwordx4 v[84:87], v15, s[30:31] sc1 nt
    global_load_dwordx4 v[88:91], v6, s[30:31] sc1 nt
    global_load_dwordx4 v[92:95], v7, s[30:31] sc1 nt
NOH1:
AW25:
    ds_read_b32 v240, v253 offset:2844
    s_waitcnt lgkmcnt(0)
    v_cmp_gt_u32 vcc, 1, v240
    s_cbranch_vccnz AW25
    global_load_dwordx4 v[24:27], v10, s[30:31] sc1
    global_load_dwordx4 v[28:31], v10, s[30:31] offset:16 sc1
    s_cmp_eq_u32 s32, 7
    s_cbranch_scc1 SW0
    global_load_dwordx4 v[96:99], v8, s[24:25] nt
    v_add_u32 v8, s42, v8
    global_load_dwordx4 v[100:103], v8, s[24:25] nt
    v_add_u32 v8, s42, v8
    global_load_dwordx4 v[104:107], v8, s[24:25] nt
    v_add_u32 v8, s42, v8
    global_load_dwordx4 v[108:111], v8, s[24:25] nt
    v_add_u32 v8, s42, v8
    global_load_dwordx4 v[112:115], v8, s[24:25] nt
    v_add_u32 v8, s42, v8
    global_load_dwordx4 v[116:119], v8, s[24:25] nt
    v_add_u32 v8, s42, v8
    global_load_dwordx4 v[120:123], v8, s[24:25] nt
    v_add_u32 v8, s42, v8
    global_load_dwordx4 v[124:127], v8, s[24:25] nt
    s_waitcnt vmcnt(10)
HCHK:
    v_xor_b32 v80, s84, v80
    v_xor_b32 v81, s85, v81
    v_xor_b32 v82, s86, v82
    v_xor_b32 v83, s87, v83
    v_xor_b32 v84, s84, v84
    v_xor_b32 v85, s85, v85
    v_xor_b32 v86, s86, v86
    v_xor_b32 v87, s87, v87
    v_xor_b32 v88, s84, v88
    v_xor_b32 v89, s85, v89
    v_xor_b32 v90, s86, v90
    v_xor_b32 v91, s87, v91
    v_xor_b32 v92, s84, v92
    v_xor_b32 v93, s85, v93
    v_xor_b32 v94, s86, v94
    v_xor_b32 v95, s87, v95
    v_or3_b32 v240, v80, v81, v82
    v_or3_b32 v240, v240, v83, v84
    v_or3_b32 v240, v240, v85, v86
    v_or3_b32 v240, v240, v87, v88
    v_or3_b32 v240, v240, v89, v90
    v_or3_b32 v240, v240, v91, v92
    v_or3_b32 v240, v240, v93, v94
    v_or_b32 v240, v240, v95
    v_and_b32 v240, 0xff, v240
    v_cmp_ne_u32 vcc, 0, v240
    s_cbranch_vccnz RS26
OK27:
    v_permlane32_swap_b32 v80, v84
    v_permlane32_swap_b32 v81, v85
    v_permlane32_swap_b32 v82, v86
    v_permlane32_swap_b32 v83, v87
    v_pk_add_f32 v[80:81], v[80:81], v[84:85]
    v_pk_add_f32 v[82:83], v[82:83], v[86:87]
    v_permlane32_swap_b32 v88, v92
    v_permlane32_swap_b32 v89, v93
    v_permlane32_swap_b32 v90, v94
    v_permlane32_swap_b32 v91, v95
    v_pk_add_f32 v[88:89], v[88:89], v[92:93]
    v_pk_add_f32 v[90:91], v[90:91], v[94:95]
    s_nop 1
    v_permlane16_swap_b32 v80, v82
    v_permlane16_swap_b32 v81, v83
    v_pk_add_f32 v[80:81], v[80:81], v[82:83]
    v_permlane16_swap_b32 v88, v90
    v_permlane16_swap_b32 v89, v91
    v_pk_add_f32 v[88:89], v[88:89], v[90:91]
    s_nop 1
    v_add_f32_dpp v80, v80, v80 row_ror:8 row_mask:0xf bank_mask:0xf
    v_add_f32_dpp v81, v81, v81 row_ror:8 row_mask:0xf bank_mask:0xf
    v_add_f32_dpp v88, v88, v88 row_ror:8 row_mask:0xf bank_mask:0xf
    v_add_f32_dpp v89, v89, v89 row_ror:8 row_mask:0xf bank_mask:0xf
    v_cvt_pk_bf16_f32 v236, v80, v81
    v_cvt_pk_bf16_f32 v237, v88, v89
    v_lshlrev_b32 v80, 16, v236
    v_and_b32 v81, 0xffff0000, v236
    v_lshlrev_b32 v88, 16, v237
    v_and_b32 v89, 0xffff0000, v237
    v_max_f32 v80, 0, v80
    v_max_f32 v81, 0, v81
PADC1:
    s_cbranch_execz PADC2
    v_mul_f32 v80, v80, v88
    v_mul_f32 v81, v81, v89
    v_cvt_pk_bf16_f32 v80, v80, v80
    v_cvt_pk_bf16_f32 v81, v81, v81
    ds_write2_b32 v22, v80, v81 offset0:0 offset1:8
    ds_read_b128 v[208:211], v23 offset:2048
    ds_read_b128 v[212:215], v23 offset:2064
    s_waitcnt lgkmcnt(0)
    v_and_b32 v144, v208, v224
    v_and_b32 v145, v208, v225
    v_and_b32 v146, v208, v226
    v_and_b32 v147, v208, v227
    v_and_b32 v148, v209, v224
    v_and_b32 v149, v209, v225
    v_and_b32 v150, v209, v226
    v_and_b32 v151, v209, v227
    v_and_b32 v152, v210, v224
    v_and_b32 v153, v210, v225
    v_and_b32 v154, v210, v226
    v_and_b32 v155, v210, v227
    v_and_b32 v156, v211, v224
    v_and_b32 v157, v211, v225
    v_and_b32 v158, v211, v226
    v_and_b32 v159, v211, v227
    v_and_b32 v160, v212, v224
    v_and_b32 v161, v212, v225
    v_and_b32 v162, v212, v226
    v_and_b32 v163, v212, v227
    v_and_b32 v164, v213, v224
    v_and_b32 v165, v213, v225
    v_and_b32 v166, v213, v226
    v_and_b32 v167, v213, v227
    v_and_b32 v168, v214, v224
    v_and_b32 v169, v214, v225
    v_and_b32 v170, v214, v226
    v_and_b32 v171, v214, v227
    v_and_b32 v172, v215, v224
    v_and_b32 v173, v215, v225
    v_and_b32 v174, v215, v226
    v_and_b32 v175, v215, v227
    s_cmp_lg_u32 s58, 0
    s_cbranch_scc1 WDM
STATS:
    s_waitcnt vmcnt(8)
SCHK:
    v_xor_b32 v24, s84, v24
    v_xor_b32 v25, s85, v25
    v_xor_b32 v26, s86, v26
    v_xor_b32 v27, s87, v27
    v_xor_b32 v28, s84, v28
    v_xor_b32 v29, s85, v29
    v_xor_b32 v30, s86, v30
    v_xor_b32 v31, s87, v31
    v_or3_b32 v240, v24, v25, v26
    v_or3_b32 v240, v240, v27, v28
    v_or3_b32 v240, v240, v29, v30
    v_or_b32 v240, v240, v31
    v_and_b32 v240, 0xff, v240
    v_cmp_ne_u32 vcc, 0, v240
    s_cbranch_vccnz RS28
OK29:
    v_mov_b32 v236, v24
    v_mov_b32 v237, v25
    v_mov_b32 v238, v26
    v_mov_b32 v239, v27
    v_max_f32_dpp v236, v236, v236 row_ror:8 row_mask:0xf bank_mask:0xf
    v_max_f32_dpp v237, v237, v237 row_ror:8 row_mask:0xf bank_mask:0xf
    v_max_f32_dpp v238, v238, v238 row_ror:8 row_mask:0xf bank_mask:0xf
    v_max_f32_dpp v239, v239, v239 row_ror:8 row_mask:0xf bank_mask:0xf
    v_max_f32_dpp v236, v236, v236 row_ror:4 row_mask:0xf bank_mask:0xf
    v_max_f32_dpp v237, v237, v237 row_ror:4 row_mask:0xf bank_mask:0xf
    v_max_f32_dpp v238, v238, v238 row_ror:4 row_mask:0xf bank_mask:0xf
    v_max_f32_dpp v239, v239, v239 row_ror:4 row_mask:0xf bank_mask:0xf
    v_max_f32_dpp v236, v236, v236 row_ror:2 row_mask:0xf bank_mask:0xf
    v_max_f32_dpp v237, v237, v237 row_ror:2 row_mask:0xf bank_mask:0xf
    v_max_f32_dpp v238, v238, v238 row_ror:2 row_mask:0xf bank_mask:0xf
    v_max_f32_dpp v239, v239, v239 row_ror:2 row_mask:0xf bank_mask:0xf
    v_max_f32_dpp v236, v236, v236 row_ror:1 row_mask:0xf bank_mask:0xf
    v_max_f32_dpp v237, v237, v237 row_ror:1 row_mask:0xf bank_mask:0xf
    v_max_f32_dpp v238, v238, v238 row_ror:1 row_mask:0xf bank_mask:0xf
    v_max_f32_dpp v239, v239, v239 row_ror:1 row_mask:0xf bank_mask:0xf
    v_sub_f32 v24, v24, v236
    v_sub_f32 v25, v25, v237
    v_sub_f32 v26, v26, v238
    v_sub_f32 v27, v27, v239
    v_mul_f32 v24, s43, v24
    v_mul_f32 v25, s43, v25
    v_mul_f32 v26, s43, v26
    v_mul_f32 v27, s43, v27
    v_exp_f32 v24, v24
    v_exp_f32 v25, v25
    v_exp_f32 v26, v26
    v_exp_f32 v27, v27
    s_nop 0
    v_mul_f32 v236, v24, v28
    v_mul_f32 v237, v25, v29
    v_mul_f32 v238, v26, v30
    v_mul_f32 v239, v27, v31
    v_add_f32_dpp v236, v236, v236 row_ror:8 row_mask:0xf bank_mask:0xf
    v_add_f32_dpp v237, v237, v237 row_ror:8 row_mask:0xf bank_mask:0xf
    v_add_f32_dpp v238, v238, v238 row_ror:8 row_mask:0xf bank_mask:0xf
    v_add_f32_dpp v239, v239, v239 row_ror:8 row_mask:0xf bank_mask:0xf
    v_add_f32_dpp v236, v236, v236 row_ror:4 row_mask:0xf bank_mask:0xf
    v_add_f32_dpp v237, v237, v237 row_ror:4 row_mask:0xf bank_mask:0xf
    v_add_f32_dpp v238, v238, v238 row_ror:4 row_mask:0xf bank_mask:0xf
    v_add_f32_dpp v239, v239, v239 row_ror:4 row_mask:0xf bank_mask:0xf
    v_add_f32_dpp v236, v236, v236 row_ror:2 row_mask:0xf bank_mask:0xf
    v_add_f32_dpp v237, v237, v237 row_ror:2 row_mask:0xf bank_mask:0xf
    v_add_f32_dpp v238, v238, v238 row_ror:2 row_mask:0xf bank_mask:0xf
    v_add_f32_dpp v239, v239, v239 row_ror:2 row_mask:0xf bank_mask:0xf
    v_add_f32_dpp v236, v236, v236 row_ror:1 row_mask:0xf bank_mask:0xf
    v_add_f32_dpp v237, v237, v237 row_ror:1 row_mask:0xf bank_mask:0xf
    v_add_f32_dpp v238, v238, v238 row_ror:1 row_mask:0xf bank_mask:0xf
    v_add_f32_dpp v239, v239, v239 row_ror:1 row_mask:0xf bank_mask:0xf
    v_rcp_f32 v236, v236
    v_rcp_f32 v237, v237
    v_rcp_f32 v238, v238
    v_rcp_f32 v239, v239
    s_nop 0
    v_mul_f32 v24, v24, v236
    v_mul_f32 v25, v25, v237
    v_mul_f32 v26, v26, v238
    v_mul_f32 v27, v27, v239
    ds_write_b128 v11, v[24:27] offset:2304
    v_mov_b32 v236, 1
    ds_write_b32 v253, v236 offset:2848
    s_cmp_eq_u32 s32, 7
    s_cbranch_scc1 NOH
    s_cmp_lg_u32 s58, 0
    s_cbranch_scc1 HAGAIN
WDM:
    s_waitcnt vmcnt(0)
    v_mfma_f32_16x16x32_bf16 v[232:235], v[144:147], v[96:99], 0
    v_mfma_f32_16x16x32_bf16 v[232:235], v[148:151], v[100:103], v[232:235]
    v_mfma_f32_16x16x32_bf16 v[232:235], v[152:155], v[104:107], v[232:235]
    v_mfma_f32_16x16x32_bf16 v[232:235], v[156:159], v[108:111], v[232:235]
    v_mfma_f32_16x16x32_bf16 v[232:235], v[160:163], v[112:115], v[232:235]
    v_mfma_f32_16x16x32_bf16 v[232:235], v[164:167], v[116:119], v[232:235]
    v_mfma_f32_16x16x32_bf16 v[232:235], v[168:171], v[120:123], v[232:235]
    v_mfma_f32_16x16x32_bf16 v[232:235], v[172:175], v[124:127], v[232:235]
NOH:
    v_lshlrev_b32 v20, 16, v20
    v_mov_b32 v254, 1
    s_nop 5
    ds_write_b128 v21, v[232:235] offset:3072
    s_mov_b64 exec, 1
    ds_add_rtn_u32 v236, v253, v254 offset:2852
    s_mov_b64 exec, -1
    ds_read_b128 v[144:147], v21 offset:12288
    ds_read_b128 v[148:151], v21 offset:13312
    ds_read_b128 v[152:155], v21 offset:14336
    ds_read_b128 v[156:159], v21 offset:15360
    ds_read_b128 v[160:163], v21 offset:3072
    s_waitcnt lgkmcnt(5)
    v_readfirstlane_b32 s4, v236
    s_cmp_lg_u32 s4, 4
    s_cbranch_scc1 NOTME
    s_waitcnt lgkmcnt(3)
    v_pk_add_f32 v[144:145], v[144:145], v[148:149]
    v_pk_add_f32 v[146:147], v[146:147], v[150:151]
    s_waitcnt lgkmcnt(1)
    v_pk_add_f32 v[152:153], v[152:153], v[156:157]
    v_pk_add_f32 v[154:155], v[154:155], v[158:159]
    s_waitcnt lgkmcnt(0)
    v_pk_add_f32 v[144:145], v[144:145], v[160:161]
    v_pk_add_f32 v[146:147], v[146:147], v[162:163]
    v_pk_add_f32 v[144:145], v[144:145], v[152:153]
    v_pk_add_f32 v[146:147], v[146:147], v[154:155]
    v_and_or_b32 v144, v144, s37, v248
    v_and_or_b32 v145, v145, s37, v249
    v_and_or_b32 v146, v146, s37, v250
    v_and_or_b32 v147, v147, s37, v251
    global_store_dwordx4 v12, v[144:147], s[30:31] sc1
    s_waitcnt vmcnt(0)
    ds_write_b32 v253, v254 offset:2856
NOTME:
    s_cmp_ge_u32 s57, 64
    s_cbranch_scc1 END
AW31:
    ds_read_b32 v240, v253 offset:2856
    s_waitcnt lgkmcnt(0)
    v_cmp_gt_u32 vcc, 1, v240
    s_cbranch_vccnz AW31
FG30:
PADC0:
    s_cbranch_execz PADC1
    global_load_dwordx4 v[80:83], v16, s[30:31] sc1
    global_load_dwordx4 v[84:87], v17, s[30:31] sc1
    global_load_dwordx4 v[88:91], v18, s[30:31] sc1
    global_load_dwordx4 v[92:95], v19, s[30:31] sc1
    s_waitcnt vmcnt(3)
    v_xor_b32 v80, s84, v80
    v_xor_b32 v81, s85, v81
    v_xor_b32 v82, s86, v82
    v_xor_b32 v83, s87, v83
    v_or3_b32 v240, v80, v81, v82
    v_or_b32 v240, v240, v83
    s_waitcnt vmcnt(2)
    v_xor_b32 v84, s84, v84
    v_xor_b32 v85, s85, v85
    v_xor_b32 v86, s86, v86
    v_xor_b32 v87, s87, v87
    v_or3_b32 v240, v240, v84, v85
    v_or3_b32 v240, v240, v86, v87
    v_pk_add_f32 v[208:209], v[80:81], v[84:85]
    v_pk_add_f32 v[210:211], v[82:83], v[86:87]
    s_waitcnt vmcnt(1)
    v_xor_b32 v88, s84, v88
    v_xor_b32 v89, s85, v89
    v_xor_b32 v90, s86, v90
    v_xor_b32 v91, s87, v91
    v_or3_b32 v240, v240, v88, v89
    v_or3_b32 v240, v240, v90, v91
    v_pk_add_f32 v[208:209], v[208:209], v[88:89]
    v_pk_add_f32 v[210:211], v[210:211], v[90:91]
    s_waitcnt vmcnt(0)
    v_xor_b32 v92, s84, v92
    v_xor_b32 v93, s85, v93
    v_xor_b32 v94, s86, v94
    v_xor_b32 v95, s87, v95
    v_or3_b32 v240, v240, v92, v93
    v_or3_b32 v240, v240, v94, v95
    v_pk_add_f32 v[208:209], v[208:209], v[92:93]
    v_pk_add_f32 v[210:211], v[210:211], v[94:95]
    v_and_b32 v240, 0xff, v240
    v_cmp_ne_u32 vcc, 0, v240
    s_cbranch_vccnz RS32
OK33:
    v_permlane32_swap_b32 v208, v210
    v_permlane32_swap_b32 v209, v211
    v_pk_add_f32 v[208:209], v[208:209], v[210:211]
    s_nop 1
    v_permlane16_swap_b32 v208, v209
    v_add_f32 v208, v208, v209
    s_nop 1
    v_add_f32_dpp v208, v208, v208 row_ror:8 row_mask:0xf bank_mask:0xf
    s_nop 1
    v_add_f32_dpp v208, v208, v208 row_ror:4 row_mask:0xf bank_mask:0xf
    v_add_f32 v208, v208, v20
    v_cvt_pk_bf16_f32 v208, v208, v208
    s_mov_b32 exec_lo, 0x000f000f
    s_mov_b32 exec_hi, 0x000f000f
    global_store_short v13, v208, s[26:27]
    s_cmp_lg_u32 s57, 0
    s_cbranch_scc1 END
    s_add_u32 s38, s38, 1
    v_mov_b32 v8, s38
    s_mov_b64 exec, 1
    global_store_dword v253, v8, s[30:31]
END:
    s_endpgm
RS15:
    s_sub_u32 s40, s40, 1
    s_cbranch_scc0 QPROBE10
    s_mov_b32 s40, 0
    s_branch OK16
CS19:
    global_store_dwordx4 v15, v[232:235], s[30:31] sc1
    s_branch CS20
CS22:
    global_store_dwordx4 v9, v[208:211], s[30:31] sc1
    s_branch CS23
RS26:
    s_sub_u32 s40, s40, 1
    s_cbranch_scc0 HFAIL
    s_mov_b32 s40, 0
    s_branch OK27
RS28:
    s_sub_u32 s40, s40, 1
    s_cbranch_scc0 SR24
    s_mov_b32 s40, 0
    s_branch OK29
SR24:
    global_load_dwordx4 v[24:27], v10, s[30:31] sc1
    global_load_dwordx4 v[28:31], v10, s[30:31] offset:16 sc1
SW0:
    s_waitcnt vmcnt(0)
    s_branch SCHK
HFAIL:
    s_cmp_lg_u32 s58, 0
    s_mov_b32 s58, 1
    s_cbranch_scc0 STATS
HAGAIN:
    global_load_dwordx4 v[80:83], v14, s[30:31] sc1 nt
    global_load_dwordx4 v[84:87], v15, s[30:31] sc1 nt
    global_load_dwordx4 v[88:91], v6, s[30:31] sc1 nt
    global_load_dwordx4 v[92:95], v7, s[30:31] sc1 nt
    s_waitcnt vmcnt(0)
    s_branch HCHK
RS32:
    s_sub_u32 s40, s40, 1
    s_cbranch_scc0 FG30
    s_mov_b32 s40, 0
    s_branch OK33
CODE_END:
.section .rodata,"a"
.p2align 6
.amdhsa_kernel parallel_sum__sliding_block_cached__glu_gated_reglu__decode_kernel
  .amdhsa_next_free_vgpr 256
  .amdhsa_next_free_sgpr 96
  .amdhsa_accum_offset 256
  .amdhsa_group_segment_fixed_size 0
  .amdhsa_kernarg_size 96
  .amdhsa_user_sgpr_count 2
  .amdhsa_user_sgpr_kernarg_segment_ptr 1
  .amdhsa_system_sgpr_workgroup_id_x 1
.end_amdhsa_kernel
```
